```python
import torch

def _softmax(x, axis=-1):
    return torch.softmax(x, dim=axis)
def _gelu(x):
    return torch.nn.functional.gelu(x, approximate="tanh")
def _silu(x):
    return torch.nn.functional.silu(x)
def _sigmoid(x):
    return torch.sigmoid(x)
def _layernorm(x, axis=-1, eps=1e-5):
    m = x.mean(dim=axis, keepdim=True)
    v = x.var(dim=axis, keepdim=True, unbiased=False)
    return (x - m) / torch.sqrt(v + eps)
def _scatter_add(tgt, idx, src, axis=0):
    return tgt.clone().index_add_(axis, idx, src)
def _segment_sum(src, seg, n):
    out = torch.zeros((n,) + src.shape[1:], dtype=src.dtype)
    return out.index_add_(0, seg, src)
def _pad(x, pw):
    flat = tuple(v for pair in reversed(pw) for v in pair)
    return torch.nn.functional.pad(x, flat)

kernel_name = 'sequential_preLN__spectral_gfnet__glu_gated_swiglu__prompt'

def setup_inputs():

    _w = (lambda a: (lambda t: t.to(torch.bfloat16) if t.is_floating_point() else t)(torch.as_tensor(a)))
    def _A_setup():
        B, S, D = 1, 2048, 640
        Df = D // 2 + 1
        return {
            "x": _w((lambda *s: torch.randn(*s, dtype=torch.bfloat16) * 0.05)(B, S, D)),
            "w_r": _w((lambda *s: torch.randn(*s, dtype=torch.bfloat16) * 0.4)(S, Df) * 0.02),
            "w_i": _w((lambda *s: torch.randn(*s, dtype=torch.bfloat16) * 0.4)(S, Df) * 0.02),
        }
    _A_in = _A_setup()

    def _B_setup():
        B, S, D, F = 1, 2048, 640, 1536
        return {
            "x": _w((lambda *s: torch.randn(*s, dtype=torch.bfloat16) * 0.05)(B, S, D)),
            "w1": _w((lambda *s: torch.randn(*s, dtype=torch.bfloat16) * 0.2)(D, F) * (2.0 / D) ** 0.5),
            "w3": _w((lambda *s: torch.randn(*s, dtype=torch.bfloat16) * 0.2)(D, F) * (2.0 / D) ** 0.5),
            "w2": _w((lambda *s: torch.randn(*s, dtype=torch.bfloat16) * 0.2)(F, D) * (2.0 / F) ** 0.5),
        }
    _B_in = _B_setup()

    return {
        "A_x": _A_in["x"],
        "A_w_r": _A_in["w_r"],
        "A_w_i": _A_in["w_i"],
        "B_x": _B_in["x"],
        "B_w1": _B_in["w1"],
        "B_w3": _B_in["w3"],
        "B_w2": _B_in["w2"],
    }

def reference(A_x, A_w_r, A_w_i, B_x, B_w1, B_w3, B_w2):
    def _A_ref(x, w_r, w_i):
        B, S, D = x.shape
        X = (lambda x, axes=(-2,-1): torch.fft.rfft2(x.float(), dim=axes))(x, axes=(-2, -1))
        W = w_r + 1j * w_i
        X = X * W
        y = (lambda x, s, axes=(-2,-1): torch.fft.irfft2(x, s=s, dim=axes).to(torch.bfloat16))(X, (S, D), axes=(-2, -1))
        return y

    def _B_ref(x, w1, w3, w2):
        gate = torch.einsum("bsd,df->bsf", x, w1)
        up = torch.einsum("bsd,df->bsf", x, w3)
        h = _silu(gate) * up
        out = torch.einsum("bsf,fd->bsd", h, w2)
        return out

    x = A_x
    h = x + _A_ref(_layernorm(x, axis=-1), A_w_r, A_w_i)
    h2 = h + _B_ref(_layernorm(h, axis=-1), B_w1, B_w3, B_w2)
    return h2
```

```asm
; @launch kernel=k1_kernel grid=(256,1,1) block=(512,1,1) lds=143360
.amdgcn_target "amdgcn-amd-amdhsa--gfx950"
.text
.globl k1_kernel
.p2align 8
.type k1_kernel,@function
k1_kernel:
    s_cmp_ge_u32 s2, 256
    s_cbranch_scc1 k1_kernel_end
    s_load_dwordx2 s[4:5], s[0:1], 0
    s_load_dwordx2 s[6:7], s[0:1], 72
    s_load_dwordx2 s[42:43], s[0:1], 64
    s_getpc_b64 s[60:61]
k1_kernel_pf1:
    v_lshlrev_b32 v254, 7, v0
    v_min_u32 v254, k1_kernel_codeend-k1_kernel_pf1-4, v254
    global_load_dword v255, v254, s[60:61]
    s_cmp_lt_u32 s2, 96
    s_cbranch_scc1 k1_kernel_side
    v_and_b32 v1, 63, v0
    v_lshrrev_b32 v2, 6, v0
    s_and_b32 s22, s2, 7
    s_lshr_b32 s23, s2, 3
    s_sub_u32 s23, s23, 12
    v_readfirstlane_b32 s21, v2
    s_mul_i32 s24, s23, 52
    s_lshr_b32 s24, s24, 8
    s_mul_i32 s25, s24, 5
    s_sub_u32 s18, s23, s25
    s_lshl_b32 s24, s24, 3
    s_add_u32 s17, s24, s22
    s_and_b32 s16, s21, 3
    s_cmp_ge_u32 s21, 4
    s_cbranch_scc1 k1_kernel_prod
    s_lshl_b32 s22, s18, 2
    s_add_u32 s22, s22, s16
    s_lshl_b32 s22, s22, 4
    s_add_u32 s22, s22, 1
    v_and_b32 v2, 15, v1
    v_add_u32 v2, s22, v2
    v_cvt_f32_u32 v18, v2
    v_bfe_u32 v3, v1, 4, 1
    v_lshl_add_u32 v12, v2, 1, v3
    v_lshlrev_b32 v12, 12, v12
    v_subrev_u32 v12, 8192, v12
    v_cvt_f32_u32 v19, v3
    v_lshrrev_b32 v3, 5, v1
    v_lshl_add_u32 v12, v3, 4, v12
    v_cvt_f32_u32 v20, v3
    v_mul_f32 v14, 0x3acccccd, v18
    v_mul_f32 v13, v20, v18
    v_mul_f32 v13, 0.5, v13
    v_mul_f32 v19, 0x3e800000, v19
    v_add_f32 v13, v13, v19
    v_fract_f32 v13, v13
    v_mul_f32 v15, 0x3d800000, v18
    v_fract_f32 v15, v15
    v_add_f32 v18, v14, v14
    v_cos_f32 v16, v18
    s_nop 0
    v_add_f32 v16, v16, v16
    v_add_f32 v24, v13, v14
    v_cos_f32 v18, v13
    v_cos_f32 v19, v24
    v_add_f32 v25, v24, v14
    v_add_f32 v24, v25, v14
    v_cos_f32 v20, v25
    v_cos_f32 v21, v24
    v_cvt_pk_bf16_f32 v84, v18, v19
    s_nop 0
    v_cvt_pk_bf16_f32 v85, v20, v21
    v_pk_fma_f32 v[22:23], v[16:17], v[20:21], v[18:19] op_sel_hi:[0,1,1] neg_lo:[0,0,1] neg_hi:[0,0,1]
    v_cvt_pk_bf16_f32 v86, v22, v23
    v_pk_fma_f32 v[18:19], v[16:17], v[22:23], v[20:21] op_sel_hi:[0,1,1] neg_lo:[0,0,1] neg_hi:[0,0,1]
    v_cvt_pk_bf16_f32 v87, v18, v19
    v_pk_fma_f32 v[20:21], v[16:17], v[18:19], v[22:23] op_sel_hi:[0,1,1] neg_lo:[0,0,1] neg_hi:[0,0,1]
    v_cvt_pk_bf16_f32 v88, v20, v21
    v_pk_fma_f32 v[22:23], v[16:17], v[20:21], v[18:19] op_sel_hi:[0,1,1] neg_lo:[0,0,1] neg_hi:[0,0,1]
    v_cvt_pk_bf16_f32 v89, v22, v23
    v_pk_fma_f32 v[18:19], v[16:17], v[22:23], v[20:21] op_sel_hi:[0,1,1] neg_lo:[0,0,1] neg_hi:[0,0,1]
    v_cvt_pk_bf16_f32 v90, v18, v19
    v_pk_fma_f32 v[20:21], v[16:17], v[18:19], v[22:23] op_sel_hi:[0,1,1] neg_lo:[0,0,1] neg_hi:[0,0,1]
    v_cvt_pk_bf16_f32 v91, v20, v21
    v_pk_fma_f32 v[22:23], v[16:17], v[20:21], v[18:19] op_sel_hi:[0,1,1] neg_lo:[0,0,1] neg_hi:[0,0,1]
    v_cvt_pk_bf16_f32 v92, v22, v23
    v_pk_fma_f32 v[18:19], v[16:17], v[22:23], v[20:21] op_sel_hi:[0,1,1] neg_lo:[0,0,1] neg_hi:[0,0,1]
    v_cvt_pk_bf16_f32 v93, v18, v19
    v_pk_fma_f32 v[20:21], v[16:17], v[18:19], v[22:23] op_sel_hi:[0,1,1] neg_lo:[0,0,1] neg_hi:[0,0,1]
    v_cvt_pk_bf16_f32 v94, v20, v21
    v_pk_fma_f32 v[22:23], v[16:17], v[20:21], v[18:19] op_sel_hi:[0,1,1] neg_lo:[0,0,1] neg_hi:[0,0,1]
    v_cvt_pk_bf16_f32 v95, v22, v23
    v_pk_fma_f32 v[18:19], v[16:17], v[22:23], v[20:21] op_sel_hi:[0,1,1] neg_lo:[0,0,1] neg_hi:[0,0,1]
    v_cvt_pk_bf16_f32 v96, v18, v19
    v_pk_fma_f32 v[20:21], v[16:17], v[18:19], v[22:23] op_sel_hi:[0,1,1] neg_lo:[0,0,1] neg_hi:[0,0,1]
    v_cvt_pk_bf16_f32 v97, v20, v21
    v_pk_fma_f32 v[22:23], v[16:17], v[20:21], v[18:19] op_sel_hi:[0,1,1] neg_lo:[0,0,1] neg_hi:[0,0,1]
    v_cvt_pk_bf16_f32 v98, v22, v23
    v_pk_fma_f32 v[18:19], v[16:17], v[22:23], v[20:21] op_sel_hi:[0,1,1] neg_lo:[0,0,1] neg_hi:[0,0,1]
    v_cvt_pk_bf16_f32 v99, v18, v19
    v_pk_fma_f32 v[20:21], v[16:17], v[18:19], v[22:23] op_sel_hi:[0,1,1] neg_lo:[0,0,1] neg_hi:[0,0,1]
    v_cvt_pk_bf16_f32 v100, v20, v21
    v_pk_fma_f32 v[22:23], v[16:17], v[20:21], v[18:19] op_sel_hi:[0,1,1] neg_lo:[0,0,1] neg_hi:[0,0,1]
    v_cvt_pk_bf16_f32 v101, v22, v23
    v_pk_fma_f32 v[18:19], v[16:17], v[22:23], v[20:21] op_sel_hi:[0,1,1] neg_lo:[0,0,1] neg_hi:[0,0,1]
    v_cvt_pk_bf16_f32 v102, v18, v19
    v_pk_fma_f32 v[20:21], v[16:17], v[18:19], v[22:23] op_sel_hi:[0,1,1] neg_lo:[0,0,1] neg_hi:[0,0,1]
    v_cvt_pk_bf16_f32 v103, v20, v21
    v_add_f32 v13, v13, v15
    v_fract_f32 v13, v13
    v_add_f32 v24, v13, v14
    v_cos_f32 v18, v13
    v_cos_f32 v19, v24
    v_add_f32 v25, v24, v14
    v_add_f32 v24, v25, v14
    v_cos_f32 v20, v25
    v_cos_f32 v21, v24
    v_cvt_pk_bf16_f32 v104, v18, v19
    s_nop 0
    v_cvt_pk_bf16_f32 v105, v20, v21
    v_pk_fma_f32 v[22:23], v[16:17], v[20:21], v[18:19] op_sel_hi:[0,1,1] neg_lo:[0,0,1] neg_hi:[0,0,1]
    v_cvt_pk_bf16_f32 v106, v22, v23
    v_pk_fma_f32 v[18:19], v[16:17], v[22:23], v[20:21] op_sel_hi:[0,1,1] neg_lo:[0,0,1] neg_hi:[0,0,1]
    v_cvt_pk_bf16_f32 v107, v18, v19
    v_pk_fma_f32 v[20:21], v[16:17], v[18:19], v[22:23] op_sel_hi:[0,1,1] neg_lo:[0,0,1] neg_hi:[0,0,1]
    v_cvt_pk_bf16_f32 v108, v20, v21
    v_pk_fma_f32 v[22:23], v[16:17], v[20:21], v[18:19] op_sel_hi:[0,1,1] neg_lo:[0,0,1] neg_hi:[0,0,1]
    v_cvt_pk_bf16_f32 v109, v22, v23
    v_pk_fma_f32 v[18:19], v[16:17], v[22:23], v[20:21] op_sel_hi:[0,1,1] neg_lo:[0,0,1] neg_hi:[0,0,1]
    v_cvt_pk_bf16_f32 v110, v18, v19
    v_pk_fma_f32 v[20:21], v[16:17], v[18:19], v[22:23] op_sel_hi:[0,1,1] neg_lo:[0,0,1] neg_hi:[0,0,1]
    v_cvt_pk_bf16_f32 v111, v20, v21
    v_pk_fma_f32 v[22:23], v[16:17], v[20:21], v[18:19] op_sel_hi:[0,1,1] neg_lo:[0,0,1] neg_hi:[0,0,1]
    v_cvt_pk_bf16_f32 v112, v22, v23
    v_pk_fma_f32 v[18:19], v[16:17], v[22:23], v[20:21] op_sel_hi:[0,1,1] neg_lo:[0,0,1] neg_hi:[0,0,1]
    v_cvt_pk_bf16_f32 v113, v18, v19
    v_pk_fma_f32 v[20:21], v[16:17], v[18:19], v[22:23] op_sel_hi:[0,1,1] neg_lo:[0,0,1] neg_hi:[0,0,1]
    v_cvt_pk_bf16_f32 v114, v20, v21
    v_pk_fma_f32 v[22:23], v[16:17], v[20:21], v[18:19] op_sel_hi:[0,1,1] neg_lo:[0,0,1] neg_hi:[0,0,1]
    v_cvt_pk_bf16_f32 v115, v22, v23
    v_pk_fma_f32 v[18:19], v[16:17], v[22:23], v[20:21] op_sel_hi:[0,1,1] neg_lo:[0,0,1] neg_hi:[0,0,1]
    v_cvt_pk_bf16_f32 v116, v18, v19
    v_pk_fma_f32 v[20:21], v[16:17], v[18:19], v[22:23] op_sel_hi:[0,1,1] neg_lo:[0,0,1] neg_hi:[0,0,1]
    v_cvt_pk_bf16_f32 v117, v20, v21
    v_pk_fma_f32 v[22:23], v[16:17], v[20:21], v[18:19] op_sel_hi:[0,1,1] neg_lo:[0,0,1] neg_hi:[0,0,1]
    v_cvt_pk_bf16_f32 v118, v22, v23
    v_pk_fma_f32 v[18:19], v[16:17], v[22:23], v[20:21] op_sel_hi:[0,1,1] neg_lo:[0,0,1] neg_hi:[0,0,1]
    v_cvt_pk_bf16_f32 v119, v18, v19
    v_pk_fma_f32 v[20:21], v[16:17], v[18:19], v[22:23] op_sel_hi:[0,1,1] neg_lo:[0,0,1] neg_hi:[0,0,1]
    v_cvt_pk_bf16_f32 v120, v20, v21
    v_pk_fma_f32 v[22:23], v[16:17], v[20:21], v[18:19] op_sel_hi:[0,1,1] neg_lo:[0,0,1] neg_hi:[0,0,1]
    v_cvt_pk_bf16_f32 v121, v22, v23
    v_pk_fma_f32 v[18:19], v[16:17], v[22:23], v[20:21] op_sel_hi:[0,1,1] neg_lo:[0,0,1] neg_hi:[0,0,1]
    v_cvt_pk_bf16_f32 v122, v18, v19
    v_pk_fma_f32 v[20:21], v[16:17], v[18:19], v[22:23] op_sel_hi:[0,1,1] neg_lo:[0,0,1] neg_hi:[0,0,1]
    v_cvt_pk_bf16_f32 v123, v20, v21
    v_add_f32 v13, v13, v15
    v_fract_f32 v13, v13
    v_add_f32 v24, v13, v14
    v_cos_f32 v18, v13
    v_cos_f32 v19, v24
    v_add_f32 v25, v24, v14
    v_add_f32 v24, v25, v14
    v_cos_f32 v20, v25
    v_cos_f32 v21, v24
    v_cvt_pk_bf16_f32 v124, v18, v19
    s_nop 0
    v_cvt_pk_bf16_f32 v125, v20, v21
    v_pk_fma_f32 v[22:23], v[16:17], v[20:21], v[18:19] op_sel_hi:[0,1,1] neg_lo:[0,0,1] neg_hi:[0,0,1]
    v_cvt_pk_bf16_f32 v126, v22, v23
    v_pk_fma_f32 v[18:19], v[16:17], v[22:23], v[20:21] op_sel_hi:[0,1,1] neg_lo:[0,0,1] neg_hi:[0,0,1]
    v_cvt_pk_bf16_f32 v127, v18, v19
    v_pk_fma_f32 v[20:21], v[16:17], v[18:19], v[22:23] op_sel_hi:[0,1,1] neg_lo:[0,0,1] neg_hi:[0,0,1]
    v_cvt_pk_bf16_f32 v128, v20, v21
    v_pk_fma_f32 v[22:23], v[16:17], v[20:21], v[18:19] op_sel_hi:[0,1,1] neg_lo:[0,0,1] neg_hi:[0,0,1]
    v_cvt_pk_bf16_f32 v129, v22, v23
    v_pk_fma_f32 v[18:19], v[16:17], v[22:23], v[20:21] op_sel_hi:[0,1,1] neg_lo:[0,0,1] neg_hi:[0,0,1]
    v_cvt_pk_bf16_f32 v130, v18, v19
    v_pk_fma_f32 v[20:21], v[16:17], v[18:19], v[22:23] op_sel_hi:[0,1,1] neg_lo:[0,0,1] neg_hi:[0,0,1]
    v_cvt_pk_bf16_f32 v131, v20, v21
    v_pk_fma_f32 v[22:23], v[16:17], v[20:21], v[18:19] op_sel_hi:[0,1,1] neg_lo:[0,0,1] neg_hi:[0,0,1]
    v_cvt_pk_bf16_f32 v132, v22, v23
    v_pk_fma_f32 v[18:19], v[16:17], v[22:23], v[20:21] op_sel_hi:[0,1,1] neg_lo:[0,0,1] neg_hi:[0,0,1]
    v_cvt_pk_bf16_f32 v133, v18, v19
    v_pk_fma_f32 v[20:21], v[16:17], v[18:19], v[22:23] op_sel_hi:[0,1,1] neg_lo:[0,0,1] neg_hi:[0,0,1]
    v_cvt_pk_bf16_f32 v134, v20, v21
    v_pk_fma_f32 v[22:23], v[16:17], v[20:21], v[18:19] op_sel_hi:[0,1,1] neg_lo:[0,0,1] neg_hi:[0,0,1]
    v_cvt_pk_bf16_f32 v135, v22, v23
    v_pk_fma_f32 v[18:19], v[16:17], v[22:23], v[20:21] op_sel_hi:[0,1,1] neg_lo:[0,0,1] neg_hi:[0,0,1]
    v_cvt_pk_bf16_f32 v136, v18, v19
    v_pk_fma_f32 v[20:21], v[16:17], v[18:19], v[22:23] op_sel_hi:[0,1,1] neg_lo:[0,0,1] neg_hi:[0,0,1]
    v_cvt_pk_bf16_f32 v137, v20, v21
    v_pk_fma_f32 v[22:23], v[16:17], v[20:21], v[18:19] op_sel_hi:[0,1,1] neg_lo:[0,0,1] neg_hi:[0,0,1]
    v_cvt_pk_bf16_f32 v138, v22, v23
    v_pk_fma_f32 v[18:19], v[16:17], v[22:23], v[20:21] op_sel_hi:[0,1,1] neg_lo:[0,0,1] neg_hi:[0,0,1]
    v_cvt_pk_bf16_f32 v139, v18, v19
    v_pk_fma_f32 v[20:21], v[16:17], v[18:19], v[22:23] op_sel_hi:[0,1,1] neg_lo:[0,0,1] neg_hi:[0,0,1]
    v_cvt_pk_bf16_f32 v140, v20, v21
    v_pk_fma_f32 v[22:23], v[16:17], v[20:21], v[18:19] op_sel_hi:[0,1,1] neg_lo:[0,0,1] neg_hi:[0,0,1]
    v_cvt_pk_bf16_f32 v141, v22, v23
    v_pk_fma_f32 v[18:19], v[16:17], v[22:23], v[20:21] op_sel_hi:[0,1,1] neg_lo:[0,0,1] neg_hi:[0,0,1]
    v_cvt_pk_bf16_f32 v142, v18, v19
    v_pk_fma_f32 v[20:21], v[16:17], v[18:19], v[22:23] op_sel_hi:[0,1,1] neg_lo:[0,0,1] neg_hi:[0,0,1]
    v_cvt_pk_bf16_f32 v143, v20, v21
    v_add_f32 v13, v13, v15
    v_fract_f32 v13, v13
    v_add_f32 v24, v13, v14
    v_cos_f32 v18, v13
    v_cos_f32 v19, v24
    v_add_f32 v25, v24, v14
    v_add_f32 v24, v25, v14
    v_cos_f32 v20, v25
    v_cos_f32 v21, v24
    v_cvt_pk_bf16_f32 v144, v18, v19
    s_nop 0
    v_cvt_pk_bf16_f32 v145, v20, v21
    v_pk_fma_f32 v[22:23], v[16:17], v[20:21], v[18:19] op_sel_hi:[0,1,1] neg_lo:[0,0,1] neg_hi:[0,0,1]
    v_cvt_pk_bf16_f32 v146, v22, v23
    v_pk_fma_f32 v[18:19], v[16:17], v[22:23], v[20:21] op_sel_hi:[0,1,1] neg_lo:[0,0,1] neg_hi:[0,0,1]
    v_cvt_pk_bf16_f32 v147, v18, v19
    v_pk_fma_f32 v[20:21], v[16:17], v[18:19], v[22:23] op_sel_hi:[0,1,1] neg_lo:[0,0,1] neg_hi:[0,0,1]
    v_cvt_pk_bf16_f32 v148, v20, v21
    v_pk_fma_f32 v[22:23], v[16:17], v[20:21], v[18:19] op_sel_hi:[0,1,1] neg_lo:[0,0,1] neg_hi:[0,0,1]
    v_cvt_pk_bf16_f32 v149, v22, v23
    v_pk_fma_f32 v[18:19], v[16:17], v[22:23], v[20:21] op_sel_hi:[0,1,1] neg_lo:[0,0,1] neg_hi:[0,0,1]
    v_cvt_pk_bf16_f32 v150, v18, v19
    v_pk_fma_f32 v[20:21], v[16:17], v[18:19], v[22:23] op_sel_hi:[0,1,1] neg_lo:[0,0,1] neg_hi:[0,0,1]
    v_cvt_pk_bf16_f32 v151, v20, v21
    v_pk_fma_f32 v[22:23], v[16:17], v[20:21], v[18:19] op_sel_hi:[0,1,1] neg_lo:[0,0,1] neg_hi:[0,0,1]
    v_cvt_pk_bf16_f32 v152, v22, v23
    v_pk_fma_f32 v[18:19], v[16:17], v[22:23], v[20:21] op_sel_hi:[0,1,1] neg_lo:[0,0,1] neg_hi:[0,0,1]
    v_cvt_pk_bf16_f32 v153, v18, v19
    v_pk_fma_f32 v[20:21], v[16:17], v[18:19], v[22:23] op_sel_hi:[0,1,1] neg_lo:[0,0,1] neg_hi:[0,0,1]
    v_cvt_pk_bf16_f32 v154, v20, v21
    v_pk_fma_f32 v[22:23], v[16:17], v[20:21], v[18:19] op_sel_hi:[0,1,1] neg_lo:[0,0,1] neg_hi:[0,0,1]
    v_cvt_pk_bf16_f32 v155, v22, v23
    v_pk_fma_f32 v[18:19], v[16:17], v[22:23], v[20:21] op_sel_hi:[0,1,1] neg_lo:[0,0,1] neg_hi:[0,0,1]
    v_cvt_pk_bf16_f32 v156, v18, v19
    v_pk_fma_f32 v[20:21], v[16:17], v[18:19], v[22:23] op_sel_hi:[0,1,1] neg_lo:[0,0,1] neg_hi:[0,0,1]
    v_cvt_pk_bf16_f32 v157, v20, v21
    v_pk_fma_f32 v[22:23], v[16:17], v[20:21], v[18:19] op_sel_hi:[0,1,1] neg_lo:[0,0,1] neg_hi:[0,0,1]
    v_cvt_pk_bf16_f32 v158, v22, v23
    v_pk_fma_f32 v[18:19], v[16:17], v[22:23], v[20:21] op_sel_hi:[0,1,1] neg_lo:[0,0,1] neg_hi:[0,0,1]
    v_cvt_pk_bf16_f32 v159, v18, v19
    v_pk_fma_f32 v[20:21], v[16:17], v[18:19], v[22:23] op_sel_hi:[0,1,1] neg_lo:[0,0,1] neg_hi:[0,0,1]
    v_cvt_pk_bf16_f32 v160, v20, v21
    v_pk_fma_f32 v[22:23], v[16:17], v[20:21], v[18:19] op_sel_hi:[0,1,1] neg_lo:[0,0,1] neg_hi:[0,0,1]
    v_cvt_pk_bf16_f32 v161, v22, v23
    v_pk_fma_f32 v[18:19], v[16:17], v[22:23], v[20:21] op_sel_hi:[0,1,1] neg_lo:[0,0,1] neg_hi:[0,0,1]
    v_cvt_pk_bf16_f32 v162, v18, v19
    v_pk_fma_f32 v[20:21], v[16:17], v[18:19], v[22:23] op_sel_hi:[0,1,1] neg_lo:[0,0,1] neg_hi:[0,0,1]
    v_cvt_pk_bf16_f32 v163, v20, v21
    v_add_f32 v13, v13, v15
    v_fract_f32 v13, v13
    v_add_f32 v24, v13, v14
    v_cos_f32 v18, v13
    v_cos_f32 v19, v24
    v_add_f32 v25, v24, v14
    v_add_f32 v24, v25, v14
    v_cos_f32 v20, v25
    v_cos_f32 v21, v24
    v_cvt_pk_bf16_f32 v164, v18, v19
    s_nop 0
    v_cvt_pk_bf16_f32 v165, v20, v21
    v_pk_fma_f32 v[22:23], v[16:17], v[20:21], v[18:19] op_sel_hi:[0,1,1] neg_lo:[0,0,1] neg_hi:[0,0,1]
    v_cvt_pk_bf16_f32 v166, v22, v23
    v_pk_fma_f32 v[18:19], v[16:17], v[22:23], v[20:21] op_sel_hi:[0,1,1] neg_lo:[0,0,1] neg_hi:[0,0,1]
    v_cvt_pk_bf16_f32 v167, v18, v19
    v_pk_fma_f32 v[20:21], v[16:17], v[18:19], v[22:23] op_sel_hi:[0,1,1] neg_lo:[0,0,1] neg_hi:[0,0,1]
    v_cvt_pk_bf16_f32 v168, v20, v21
    v_pk_fma_f32 v[22:23], v[16:17], v[20:21], v[18:19] op_sel_hi:[0,1,1] neg_lo:[0,0,1] neg_hi:[0,0,1]
    v_cvt_pk_bf16_f32 v169, v22, v23
    v_pk_fma_f32 v[18:19], v[16:17], v[22:23], v[20:21] op_sel_hi:[0,1,1] neg_lo:[0,0,1] neg_hi:[0,0,1]
    v_cvt_pk_bf16_f32 v170, v18, v19
    v_pk_fma_f32 v[20:21], v[16:17], v[18:19], v[22:23] op_sel_hi:[0,1,1] neg_lo:[0,0,1] neg_hi:[0,0,1]
    v_cvt_pk_bf16_f32 v171, v20, v21
    v_pk_fma_f32 v[22:23], v[16:17], v[20:21], v[18:19] op_sel_hi:[0,1,1] neg_lo:[0,0,1] neg_hi:[0,0,1]
    v_cvt_pk_bf16_f32 v172, v22, v23
    v_pk_fma_f32 v[18:19], v[16:17], v[22:23], v[20:21] op_sel_hi:[0,1,1] neg_lo:[0,0,1] neg_hi:[0,0,1]
    v_cvt_pk_bf16_f32 v173, v18, v19
    v_pk_fma_f32 v[20:21], v[16:17], v[18:19], v[22:23] op_sel_hi:[0,1,1] neg_lo:[0,0,1] neg_hi:[0,0,1]
    v_cvt_pk_bf16_f32 v174, v20, v21
    v_pk_fma_f32 v[22:23], v[16:17], v[20:21], v[18:19] op_sel_hi:[0,1,1] neg_lo:[0,0,1] neg_hi:[0,0,1]
    v_cvt_pk_bf16_f32 v175, v22, v23
    v_pk_fma_f32 v[18:19], v[16:17], v[22:23], v[20:21] op_sel_hi:[0,1,1] neg_lo:[0,0,1] neg_hi:[0,0,1]
    v_cvt_pk_bf16_f32 v176, v18, v19
    v_pk_fma_f32 v[20:21], v[16:17], v[18:19], v[22:23] op_sel_hi:[0,1,1] neg_lo:[0,0,1] neg_hi:[0,0,1]
    v_cvt_pk_bf16_f32 v177, v20, v21
    v_pk_fma_f32 v[22:23], v[16:17], v[20:21], v[18:19] op_sel_hi:[0,1,1] neg_lo:[0,0,1] neg_hi:[0,0,1]
    v_cvt_pk_bf16_f32 v178, v22, v23
    v_pk_fma_f32 v[18:19], v[16:17], v[22:23], v[20:21] op_sel_hi:[0,1,1] neg_lo:[0,0,1] neg_hi:[0,0,1]
    v_cvt_pk_bf16_f32 v179, v18, v19
    v_pk_fma_f32 v[20:21], v[16:17], v[18:19], v[22:23] op_sel_hi:[0,1,1] neg_lo:[0,0,1] neg_hi:[0,0,1]
    v_cvt_pk_bf16_f32 v180, v20, v21
    v_pk_fma_f32 v[22:23], v[16:17], v[20:21], v[18:19] op_sel_hi:[0,1,1] neg_lo:[0,0,1] neg_hi:[0,0,1]
    v_cvt_pk_bf16_f32 v181, v22, v23
    v_pk_fma_f32 v[18:19], v[16:17], v[22:23], v[20:21] op_sel_hi:[0,1,1] neg_lo:[0,0,1] neg_hi:[0,0,1]
    v_cvt_pk_bf16_f32 v182, v18, v19
    v_pk_fma_f32 v[20:21], v[16:17], v[18:19], v[22:23] op_sel_hi:[0,1,1] neg_lo:[0,0,1] neg_hi:[0,0,1]
    v_cvt_pk_bf16_f32 v183, v20, v21
    v_add_f32 v13, v13, v15
    v_fract_f32 v13, v13
    v_add_f32 v24, v13, v14
    v_cos_f32 v18, v13
    v_cos_f32 v19, v24
    v_add_f32 v25, v24, v14
    v_add_f32 v24, v25, v14
    v_cos_f32 v20, v25
    v_cos_f32 v21, v24
    v_cvt_pk_bf16_f32 v184, v18, v19
    s_nop 0
    v_cvt_pk_bf16_f32 v185, v20, v21
    v_pk_fma_f32 v[22:23], v[16:17], v[20:21], v[18:19] op_sel_hi:[0,1,1] neg_lo:[0,0,1] neg_hi:[0,0,1]
    v_cvt_pk_bf16_f32 v186, v22, v23
    v_pk_fma_f32 v[18:19], v[16:17], v[22:23], v[20:21] op_sel_hi:[0,1,1] neg_lo:[0,0,1] neg_hi:[0,0,1]
    v_cvt_pk_bf16_f32 v187, v18, v19
    v_pk_fma_f32 v[20:21], v[16:17], v[18:19], v[22:23] op_sel_hi:[0,1,1] neg_lo:[0,0,1] neg_hi:[0,0,1]
    v_cvt_pk_bf16_f32 v188, v20, v21
    v_pk_fma_f32 v[22:23], v[16:17], v[20:21], v[18:19] op_sel_hi:[0,1,1] neg_lo:[0,0,1] neg_hi:[0,0,1]
    v_cvt_pk_bf16_f32 v189, v22, v23
    v_pk_fma_f32 v[18:19], v[16:17], v[22:23], v[20:21] op_sel_hi:[0,1,1] neg_lo:[0,0,1] neg_hi:[0,0,1]
    v_cvt_pk_bf16_f32 v190, v18, v19
    v_pk_fma_f32 v[20:21], v[16:17], v[18:19], v[22:23] op_sel_hi:[0,1,1] neg_lo:[0,0,1] neg_hi:[0,0,1]
    v_cvt_pk_bf16_f32 v191, v20, v21
    v_pk_fma_f32 v[22:23], v[16:17], v[20:21], v[18:19] op_sel_hi:[0,1,1] neg_lo:[0,0,1] neg_hi:[0,0,1]
    v_cvt_pk_bf16_f32 v192, v22, v23
    v_pk_fma_f32 v[18:19], v[16:17], v[22:23], v[20:21] op_sel_hi:[0,1,1] neg_lo:[0,0,1] neg_hi:[0,0,1]
    v_cvt_pk_bf16_f32 v193, v18, v19
    v_pk_fma_f32 v[20:21], v[16:17], v[18:19], v[22:23] op_sel_hi:[0,1,1] neg_lo:[0,0,1] neg_hi:[0,0,1]
    v_cvt_pk_bf16_f32 v194, v20, v21
    v_pk_fma_f32 v[22:23], v[16:17], v[20:21], v[18:19] op_sel_hi:[0,1,1] neg_lo:[0,0,1] neg_hi:[0,0,1]
    v_cvt_pk_bf16_f32 v195, v22, v23
    v_pk_fma_f32 v[18:19], v[16:17], v[22:23], v[20:21] op_sel_hi:[0,1,1] neg_lo:[0,0,1] neg_hi:[0,0,1]
    v_cvt_pk_bf16_f32 v196, v18, v19
    v_pk_fma_f32 v[20:21], v[16:17], v[18:19], v[22:23] op_sel_hi:[0,1,1] neg_lo:[0,0,1] neg_hi:[0,0,1]
    v_cvt_pk_bf16_f32 v197, v20, v21
    v_pk_fma_f32 v[22:23], v[16:17], v[20:21], v[18:19] op_sel_hi:[0,1,1] neg_lo:[0,0,1] neg_hi:[0,0,1]
    v_cvt_pk_bf16_f32 v198, v22, v23
    v_pk_fma_f32 v[18:19], v[16:17], v[22:23], v[20:21] op_sel_hi:[0,1,1] neg_lo:[0,0,1] neg_hi:[0,0,1]
    v_cvt_pk_bf16_f32 v199, v18, v19
    v_pk_fma_f32 v[20:21], v[16:17], v[18:19], v[22:23] op_sel_hi:[0,1,1] neg_lo:[0,0,1] neg_hi:[0,0,1]
    v_cvt_pk_bf16_f32 v200, v20, v21
    v_pk_fma_f32 v[22:23], v[16:17], v[20:21], v[18:19] op_sel_hi:[0,1,1] neg_lo:[0,0,1] neg_hi:[0,0,1]
    v_cvt_pk_bf16_f32 v201, v22, v23
    v_pk_fma_f32 v[18:19], v[16:17], v[22:23], v[20:21] op_sel_hi:[0,1,1] neg_lo:[0,0,1] neg_hi:[0,0,1]
    v_cvt_pk_bf16_f32 v202, v18, v19
    v_pk_fma_f32 v[20:21], v[16:17], v[18:19], v[22:23] op_sel_hi:[0,1,1] neg_lo:[0,0,1] neg_hi:[0,0,1]
    v_cvt_pk_bf16_f32 v203, v20, v21
    v_add_f32 v13, v13, v15
    v_fract_f32 v13, v13
    v_add_f32 v24, v13, v14
    v_cos_f32 v18, v13
    v_cos_f32 v19, v24
    v_add_f32 v25, v24, v14
    v_add_f32 v24, v25, v14
    v_cos_f32 v20, v25
    v_cos_f32 v21, v24
    v_cvt_pk_bf16_f32 v204, v18, v19
    s_nop 0
    v_cvt_pk_bf16_f32 v205, v20, v21
    v_pk_fma_f32 v[22:23], v[16:17], v[20:21], v[18:19] op_sel_hi:[0,1,1] neg_lo:[0,0,1] neg_hi:[0,0,1]
    v_cvt_pk_bf16_f32 v206, v22, v23
    v_pk_fma_f32 v[18:19], v[16:17], v[22:23], v[20:21] op_sel_hi:[0,1,1] neg_lo:[0,0,1] neg_hi:[0,0,1]
    v_cvt_pk_bf16_f32 v207, v18, v19
    v_pk_fma_f32 v[20:21], v[16:17], v[18:19], v[22:23] op_sel_hi:[0,1,1] neg_lo:[0,0,1] neg_hi:[0,0,1]
    v_cvt_pk_bf16_f32 v208, v20, v21
    v_pk_fma_f32 v[22:23], v[16:17], v[20:21], v[18:19] op_sel_hi:[0,1,1] neg_lo:[0,0,1] neg_hi:[0,0,1]
    v_cvt_pk_bf16_f32 v209, v22, v23
    v_pk_fma_f32 v[18:19], v[16:17], v[22:23], v[20:21] op_sel_hi:[0,1,1] neg_lo:[0,0,1] neg_hi:[0,0,1]
    v_cvt_pk_bf16_f32 v210, v18, v19
    v_pk_fma_f32 v[20:21], v[16:17], v[18:19], v[22:23] op_sel_hi:[0,1,1] neg_lo:[0,0,1] neg_hi:[0,0,1]
    v_cvt_pk_bf16_f32 v211, v20, v21
    v_pk_fma_f32 v[22:23], v[16:17], v[20:21], v[18:19] op_sel_hi:[0,1,1] neg_lo:[0,0,1] neg_hi:[0,0,1]
    v_cvt_pk_bf16_f32 v212, v22, v23
    v_pk_fma_f32 v[18:19], v[16:17], v[22:23], v[20:21] op_sel_hi:[0,1,1] neg_lo:[0,0,1] neg_hi:[0,0,1]
    v_cvt_pk_bf16_f32 v213, v18, v19
    v_pk_fma_f32 v[20:21], v[16:17], v[18:19], v[22:23] op_sel_hi:[0,1,1] neg_lo:[0,0,1] neg_hi:[0,0,1]
    v_cvt_pk_bf16_f32 v214, v20, v21
    v_pk_fma_f32 v[22:23], v[16:17], v[20:21], v[18:19] op_sel_hi:[0,1,1] neg_lo:[0,0,1] neg_hi:[0,0,1]
    v_cvt_pk_bf16_f32 v215, v22, v23
    v_pk_fma_f32 v[18:19], v[16:17], v[22:23], v[20:21] op_sel_hi:[0,1,1] neg_lo:[0,0,1] neg_hi:[0,0,1]
    v_cvt_pk_bf16_f32 v216, v18, v19
    v_pk_fma_f32 v[20:21], v[16:17], v[18:19], v[22:23] op_sel_hi:[0,1,1] neg_lo:[0,0,1] neg_hi:[0,0,1]
    v_cvt_pk_bf16_f32 v217, v20, v21
    v_pk_fma_f32 v[22:23], v[16:17], v[20:21], v[18:19] op_sel_hi:[0,1,1] neg_lo:[0,0,1] neg_hi:[0,0,1]
    v_cvt_pk_bf16_f32 v218, v22, v23
    v_pk_fma_f32 v[18:19], v[16:17], v[22:23], v[20:21] op_sel_hi:[0,1,1] neg_lo:[0,0,1] neg_hi:[0,0,1]
    v_cvt_pk_bf16_f32 v219, v18, v19
    v_pk_fma_f32 v[20:21], v[16:17], v[18:19], v[22:23] op_sel_hi:[0,1,1] neg_lo:[0,0,1] neg_hi:[0,0,1]
    v_cvt_pk_bf16_f32 v220, v20, v21
    v_pk_fma_f32 v[22:23], v[16:17], v[20:21], v[18:19] op_sel_hi:[0,1,1] neg_lo:[0,0,1] neg_hi:[0,0,1]
    v_cvt_pk_bf16_f32 v221, v22, v23
    v_pk_fma_f32 v[18:19], v[16:17], v[22:23], v[20:21] op_sel_hi:[0,1,1] neg_lo:[0,0,1] neg_hi:[0,0,1]
    v_cvt_pk_bf16_f32 v222, v18, v19
    v_pk_fma_f32 v[20:21], v[16:17], v[18:19], v[22:23] op_sel_hi:[0,1,1] neg_lo:[0,0,1] neg_hi:[0,0,1]
    v_cvt_pk_bf16_f32 v223, v20, v21
    v_add_f32 v13, v13, v15
    v_fract_f32 v13, v13
    v_add_f32 v24, v13, v14
    v_cos_f32 v18, v13
    v_cos_f32 v19, v24
    v_add_f32 v25, v24, v14
    v_add_f32 v24, v25, v14
    v_cos_f32 v20, v25
    v_cos_f32 v21, v24
    v_cvt_pk_bf16_f32 v224, v18, v19
    s_nop 0
    v_cvt_pk_bf16_f32 v225, v20, v21
    v_pk_fma_f32 v[22:23], v[16:17], v[20:21], v[18:19] op_sel_hi:[0,1,1] neg_lo:[0,0,1] neg_hi:[0,0,1]
    v_cvt_pk_bf16_f32 v226, v22, v23
    v_pk_fma_f32 v[18:19], v[16:17], v[22:23], v[20:21] op_sel_hi:[0,1,1] neg_lo:[0,0,1] neg_hi:[0,0,1]
    v_cvt_pk_bf16_f32 v227, v18, v19
    v_pk_fma_f32 v[20:21], v[16:17], v[18:19], v[22:23] op_sel_hi:[0,1,1] neg_lo:[0,0,1] neg_hi:[0,0,1]
    v_cvt_pk_bf16_f32 v228, v20, v21
    v_pk_fma_f32 v[22:23], v[16:17], v[20:21], v[18:19] op_sel_hi:[0,1,1] neg_lo:[0,0,1] neg_hi:[0,0,1]
    v_cvt_pk_bf16_f32 v229, v22, v23
    v_pk_fma_f32 v[18:19], v[16:17], v[22:23], v[20:21] op_sel_hi:[0,1,1] neg_lo:[0,0,1] neg_hi:[0,0,1]
    v_cvt_pk_bf16_f32 v230, v18, v19
    v_pk_fma_f32 v[20:21], v[16:17], v[18:19], v[22:23] op_sel_hi:[0,1,1] neg_lo:[0,0,1] neg_hi:[0,0,1]
    v_cvt_pk_bf16_f32 v231, v20, v21
    v_pk_fma_f32 v[22:23], v[16:17], v[20:21], v[18:19] op_sel_hi:[0,1,1] neg_lo:[0,0,1] neg_hi:[0,0,1]
    v_cvt_pk_bf16_f32 v232, v22, v23
    v_pk_fma_f32 v[18:19], v[16:17], v[22:23], v[20:21] op_sel_hi:[0,1,1] neg_lo:[0,0,1] neg_hi:[0,0,1]
    v_cvt_pk_bf16_f32 v233, v18, v19
    v_pk_fma_f32 v[20:21], v[16:17], v[18:19], v[22:23] op_sel_hi:[0,1,1] neg_lo:[0,0,1] neg_hi:[0,0,1]
    v_cvt_pk_bf16_f32 v234, v20, v21
    v_pk_fma_f32 v[22:23], v[16:17], v[20:21], v[18:19] op_sel_hi:[0,1,1] neg_lo:[0,0,1] neg_hi:[0,0,1]
    v_cvt_pk_bf16_f32 v235, v22, v23
    v_pk_fma_f32 v[18:19], v[16:17], v[22:23], v[20:21] op_sel_hi:[0,1,1] neg_lo:[0,0,1] neg_hi:[0,0,1]
    v_cvt_pk_bf16_f32 v236, v18, v19
    v_pk_fma_f32 v[20:21], v[16:17], v[18:19], v[22:23] op_sel_hi:[0,1,1] neg_lo:[0,0,1] neg_hi:[0,0,1]
    v_cvt_pk_bf16_f32 v237, v20, v21
    v_pk_fma_f32 v[22:23], v[16:17], v[20:21], v[18:19] op_sel_hi:[0,1,1] neg_lo:[0,0,1] neg_hi:[0,0,1]
    v_cvt_pk_bf16_f32 v238, v22, v23
    v_pk_fma_f32 v[18:19], v[16:17], v[22:23], v[20:21] op_sel_hi:[0,1,1] neg_lo:[0,0,1] neg_hi:[0,0,1]
    v_cvt_pk_bf16_f32 v239, v18, v19
    v_pk_fma_f32 v[20:21], v[16:17], v[18:19], v[22:23] op_sel_hi:[0,1,1] neg_lo:[0,0,1] neg_hi:[0,0,1]
    v_cvt_pk_bf16_f32 v240, v20, v21
    v_pk_fma_f32 v[22:23], v[16:17], v[20:21], v[18:19] op_sel_hi:[0,1,1] neg_lo:[0,0,1] neg_hi:[0,0,1]
    v_cvt_pk_bf16_f32 v241, v22, v23
    v_pk_fma_f32 v[18:19], v[16:17], v[22:23], v[20:21] op_sel_hi:[0,1,1] neg_lo:[0,0,1] neg_hi:[0,0,1]
    v_cvt_pk_bf16_f32 v242, v18, v19
    v_pk_fma_f32 v[20:21], v[16:17], v[18:19], v[22:23] op_sel_hi:[0,1,1] neg_lo:[0,0,1] neg_hi:[0,0,1]
    v_cvt_pk_bf16_f32 v243, v20, v21
    v_and_b32 v2, 19, v1
    v_bfe_u32 v3, v1, 2, 1
    v_lshl_or_b32 v2, v3, 3, v2
    v_bfe_u32 v3, v1, 3, 1
    v_lshl_or_b32 v2, v3, 2, v2
    v_bfe_u32 v3, v2, 1, 3
    v_lshlrev_b32 v3, 4, v3
    v_lshl_or_b32 v3, v2, 7, v3
    v_lshrrev_b32 v18, 5, v1
    v_mul_u32_u24 v18, 40960, v18
    v_add_u32 v4, v3, v18
    v_xor_b32 v5, 16, v4
    v_xor_b32 v6, 32, v4
    v_xor_b32 v7, 48, v4
    v_xor_b32 v8, 64, v4
    v_xor_b32 v9, 80, v4
    v_xor_b32 v10, 96, v4
    v_xor_b32 v11, 112, v4
    s_waitcnt lgkmcnt(0)
    s_mov_b32 s12, s6
    s_mov_b32 s13, s7
    s_mov_b32 s14, 24772608
    s_mov_b32 s15, 0x00020000
    s_barrier
    ds_read_b128 v[28:31], v4 offset:0
    ds_read_b128 v[32:35], v4 offset:4096
    ds_read_b128 v[36:39], v5 offset:0
    ds_read_b128 v[40:43], v5 offset:4096
    s_mov_b32 s36, s42
    s_mov_b32 s37, s43
    s_mov_b32 s38, 256
    s_mov_b32 s39, 0x00020000
    ds_read_b128 v[44:47], v6 offset:0
    ds_read_b128 v[48:51], v6 offset:4096
    s_waitcnt lgkmcnt(4)
    v_mfma_f32_32x32x16_bf16 v[52:67], v[28:31], v[84:87], 0
    v_mfma_f32_32x32x16_bf16 v[68:83], v[32:35], v[84:87], 0
    ds_read_b128 v[28:31], v7 offset:0
    ds_read_b128 v[32:35], v7 offset:4096
    s_waitcnt lgkmcnt(4)
    v_mfma_f32_32x32x16_bf16 v[52:67], v[36:39], v[88:91], v[52:67]
    v_mfma_f32_32x32x16_bf16 v[68:83], v[40:43], v[88:91], v[68:83]
    ds_read_b128 v[36:39], v8 offset:0
    ds_read_b128 v[40:43], v8 offset:4096
    s_waitcnt lgkmcnt(4)
    v_mfma_f32_32x32x16_bf16 v[52:67], v[44:47], v[92:95], v[52:67]
    v_mfma_f32_32x32x16_bf16 v[68:83], v[48:51], v[92:95], v[68:83]
    ds_read_b128 v[44:47], v9 offset:0
    ds_read_b128 v[48:51], v9 offset:4096
    s_waitcnt lgkmcnt(4)
    v_mfma_f32_32x32x16_bf16 v[52:67], v[28:31], v[96:99], v[52:67]
    v_mfma_f32_32x32x16_bf16 v[68:83], v[32:35], v[96:99], v[68:83]
    ds_read_b128 v[28:31], v10 offset:0
    ds_read_b128 v[32:35], v10 offset:4096
    s_waitcnt lgkmcnt(4)
    v_mfma_f32_32x32x16_bf16 v[52:67], v[36:39], v[100:103], v[52:67]
    v_mfma_f32_32x32x16_bf16 v[68:83], v[40:43], v[100:103], v[68:83]
    ds_read_b128 v[36:39], v11 offset:0
    ds_read_b128 v[40:43], v11 offset:4096
    s_waitcnt lgkmcnt(4)
    v_mfma_f32_32x32x16_bf16 v[52:67], v[44:47], v[104:107], v[52:67]
    v_mfma_f32_32x32x16_bf16 v[68:83], v[48:51], v[104:107], v[68:83]
    s_barrier
    ds_read_b128 v[44:47], v4 offset:8192
    ds_read_b128 v[48:51], v4 offset:12288
    s_waitcnt lgkmcnt(4)
    v_mfma_f32_32x32x16_bf16 v[52:67], v[28:31], v[108:111], v[52:67]
    v_mfma_f32_32x32x16_bf16 v[68:83], v[32:35], v[108:111], v[68:83]
    ds_read_b128 v[28:31], v5 offset:8192
    ds_read_b128 v[32:35], v5 offset:12288
    s_waitcnt lgkmcnt(4)
    v_mfma_f32_32x32x16_bf16 v[52:67], v[36:39], v[112:115], v[52:67]
    v_mfma_f32_32x32x16_bf16 v[68:83], v[40:43], v[112:115], v[68:83]
    ds_read_b128 v[36:39], v6 offset:8192
    ds_read_b128 v[40:43], v6 offset:12288
    s_waitcnt lgkmcnt(4)
    v_mfma_f32_32x32x16_bf16 v[52:67], v[44:47], v[116:119], v[52:67]
    v_mfma_f32_32x32x16_bf16 v[68:83], v[48:51], v[116:119], v[68:83]
    ds_read_b128 v[44:47], v7 offset:8192
    ds_read_b128 v[48:51], v7 offset:12288
    s_waitcnt lgkmcnt(4)
    v_mfma_f32_32x32x16_bf16 v[52:67], v[28:31], v[120:123], v[52:67]
    v_mfma_f32_32x32x16_bf16 v[68:83], v[32:35], v[120:123], v[68:83]
    ds_read_b128 v[28:31], v8 offset:8192
    ds_read_b128 v[32:35], v8 offset:12288
    s_waitcnt lgkmcnt(4)
    v_mfma_f32_32x32x16_bf16 v[52:67], v[36:39], v[124:127], v[52:67]
    v_mfma_f32_32x32x16_bf16 v[68:83], v[40:43], v[124:127], v[68:83]
    ds_read_b128 v[36:39], v9 offset:8192
    ds_read_b128 v[40:43], v9 offset:12288
    s_waitcnt lgkmcnt(4)
    v_mfma_f32_32x32x16_bf16 v[52:67], v[44:47], v[128:131], v[52:67]
    v_mfma_f32_32x32x16_bf16 v[68:83], v[48:51], v[128:131], v[68:83]
    ds_read_b128 v[44:47], v10 offset:8192
    ds_read_b128 v[48:51], v10 offset:12288
    s_waitcnt lgkmcnt(4)
    v_mfma_f32_32x32x16_bf16 v[52:67], v[28:31], v[132:135], v[52:67]
    v_mfma_f32_32x32x16_bf16 v[68:83], v[32:35], v[132:135], v[68:83]
    ds_read_b128 v[28:31], v11 offset:8192
    ds_read_b128 v[32:35], v11 offset:12288
    s_waitcnt lgkmcnt(4)
    v_mfma_f32_32x32x16_bf16 v[52:67], v[36:39], v[136:139], v[52:67]
    v_mfma_f32_32x32x16_bf16 v[68:83], v[40:43], v[136:139], v[68:83]
    s_barrier
    ds_read_b128 v[36:39], v4 offset:16384
    ds_read_b128 v[40:43], v4 offset:20480
    s_waitcnt lgkmcnt(4)
    v_mfma_f32_32x32x16_bf16 v[52:67], v[44:47], v[140:143], v[52:67]
    v_mfma_f32_32x32x16_bf16 v[68:83], v[48:51], v[140:143], v[68:83]
    ds_read_b128 v[44:47], v5 offset:16384
    ds_read_b128 v[48:51], v5 offset:20480
    s_waitcnt lgkmcnt(4)
    v_mfma_f32_32x32x16_bf16 v[52:67], v[28:31], v[144:147], v[52:67]
    v_mfma_f32_32x32x16_bf16 v[68:83], v[32:35], v[144:147], v[68:83]
    ds_read_b128 v[28:31], v6 offset:16384
    ds_read_b128 v[32:35], v6 offset:20480
    s_waitcnt lgkmcnt(4)
    v_mfma_f32_32x32x16_bf16 v[52:67], v[36:39], v[148:151], v[52:67]
    v_mfma_f32_32x32x16_bf16 v[68:83], v[40:43], v[148:151], v[68:83]
    ds_read_b128 v[36:39], v7 offset:16384
    ds_read_b128 v[40:43], v7 offset:20480
    s_waitcnt lgkmcnt(4)
    v_mfma_f32_32x32x16_bf16 v[52:67], v[44:47], v[152:155], v[52:67]
    v_mfma_f32_32x32x16_bf16 v[68:83], v[48:51], v[152:155], v[68:83]
    ds_read_b128 v[44:47], v8 offset:16384
    ds_read_b128 v[48:51], v8 offset:20480
    s_waitcnt lgkmcnt(4)
    v_mfma_f32_32x32x16_bf16 v[52:67], v[28:31], v[156:159], v[52:67]
    v_mfma_f32_32x32x16_bf16 v[68:83], v[32:35], v[156:159], v[68:83]
    ds_read_b128 v[28:31], v9 offset:16384
    ds_read_b128 v[32:35], v9 offset:20480
    s_waitcnt lgkmcnt(4)
    v_mfma_f32_32x32x16_bf16 v[52:67], v[36:39], v[160:163], v[52:67]
    v_mfma_f32_32x32x16_bf16 v[68:83], v[40:43], v[160:163], v[68:83]
    ds_read_b128 v[36:39], v10 offset:16384
    ds_read_b128 v[40:43], v10 offset:20480
    s_waitcnt lgkmcnt(4)
    v_mfma_f32_32x32x16_bf16 v[52:67], v[44:47], v[164:167], v[52:67]
    v_mfma_f32_32x32x16_bf16 v[68:83], v[48:51], v[164:167], v[68:83]
    ds_read_b128 v[44:47], v11 offset:16384
    ds_read_b128 v[48:51], v11 offset:20480
    s_waitcnt lgkmcnt(4)
    v_mfma_f32_32x32x16_bf16 v[52:67], v[28:31], v[168:171], v[52:67]
    v_mfma_f32_32x32x16_bf16 v[68:83], v[32:35], v[168:171], v[68:83]
    s_barrier
    ds_read_b128 v[28:31], v4 offset:24576
    ds_read_b128 v[32:35], v4 offset:28672
    s_waitcnt lgkmcnt(4)
    v_mfma_f32_32x32x16_bf16 v[52:67], v[36:39], v[172:175], v[52:67]
    v_mfma_f32_32x32x16_bf16 v[68:83], v[40:43], v[172:175], v[68:83]
    ds_read_b128 v[36:39], v5 offset:24576
    ds_read_b128 v[40:43], v5 offset:28672
    s_waitcnt lgkmcnt(4)
    v_mfma_f32_32x32x16_bf16 v[52:67], v[44:47], v[176:179], v[52:67]
    v_mfma_f32_32x32x16_bf16 v[68:83], v[48:51], v[176:179], v[68:83]
    ds_read_b128 v[44:47], v6 offset:24576
    ds_read_b128 v[48:51], v6 offset:28672
    s_waitcnt lgkmcnt(4)
    v_mfma_f32_32x32x16_bf16 v[52:67], v[28:31], v[180:183], v[52:67]
    v_mfma_f32_32x32x16_bf16 v[68:83], v[32:35], v[180:183], v[68:83]
    ds_read_b128 v[28:31], v7 offset:24576
    ds_read_b128 v[32:35], v7 offset:28672
    s_waitcnt lgkmcnt(4)
    v_mfma_f32_32x32x16_bf16 v[52:67], v[36:39], v[184:187], v[52:67]
    v_mfma_f32_32x32x16_bf16 v[68:83], v[40:43], v[184:187], v[68:83]
    ds_read_b128 v[36:39], v8 offset:24576
    ds_read_b128 v[40:43], v8 offset:28672
    s_waitcnt lgkmcnt(4)
    v_mfma_f32_32x32x16_bf16 v[52:67], v[44:47], v[188:191], v[52:67]
    v_mfma_f32_32x32x16_bf16 v[68:83], v[48:51], v[188:191], v[68:83]
    ds_read_b128 v[44:47], v9 offset:24576
    ds_read_b128 v[48:51], v9 offset:28672
    s_waitcnt lgkmcnt(4)
    v_mfma_f32_32x32x16_bf16 v[52:67], v[28:31], v[192:195], v[52:67]
    v_mfma_f32_32x32x16_bf16 v[68:83], v[32:35], v[192:195], v[68:83]
    buffer_load_dword v2, off, s[36:39], 0 sc1
    ds_read_b128 v[28:31], v10 offset:24576
    ds_read_b128 v[32:35], v10 offset:28672
    s_waitcnt lgkmcnt(4)
    v_mfma_f32_32x32x16_bf16 v[52:67], v[36:39], v[196:199], v[52:67]
    v_mfma_f32_32x32x16_bf16 v[68:83], v[40:43], v[196:199], v[68:83]
    ds_read_b128 v[36:39], v11 offset:24576
    ds_read_b128 v[40:43], v11 offset:28672
    s_waitcnt lgkmcnt(4)
    v_mfma_f32_32x32x16_bf16 v[52:67], v[44:47], v[200:203], v[52:67]
    v_mfma_f32_32x32x16_bf16 v[68:83], v[48:51], v[200:203], v[68:83]
    s_barrier
    ds_read_b128 v[44:47], v4 offset:32768
    ds_read_b128 v[48:51], v4 offset:36864
    s_waitcnt lgkmcnt(4)
    v_mfma_f32_32x32x16_bf16 v[52:67], v[28:31], v[204:207], v[52:67]
    v_mfma_f32_32x32x16_bf16 v[68:83], v[32:35], v[204:207], v[68:83]
    ds_read_b128 v[28:31], v5 offset:32768
    ds_read_b128 v[32:35], v5 offset:36864
    s_waitcnt lgkmcnt(4)
    v_mfma_f32_32x32x16_bf16 v[52:67], v[36:39], v[208:211], v[52:67]
    v_mfma_f32_32x32x16_bf16 v[68:83], v[40:43], v[208:211], v[68:83]
    ds_read_b128 v[36:39], v6 offset:32768
    ds_read_b128 v[40:43], v6 offset:36864
    s_waitcnt lgkmcnt(4)
    v_mfma_f32_32x32x16_bf16 v[52:67], v[44:47], v[212:215], v[52:67]
    v_mfma_f32_32x32x16_bf16 v[68:83], v[48:51], v[212:215], v[68:83]
    ds_read_b128 v[44:47], v7 offset:32768
    ds_read_b128 v[48:51], v7 offset:36864
    s_waitcnt lgkmcnt(4)
    v_mfma_f32_32x32x16_bf16 v[52:67], v[28:31], v[216:219], v[52:67]
    v_mfma_f32_32x32x16_bf16 v[68:83], v[32:35], v[216:219], v[68:83]
    ds_read_b128 v[28:31], v8 offset:32768
    ds_read_b128 v[32:35], v8 offset:36864
    s_waitcnt lgkmcnt(4)
    v_mfma_f32_32x32x16_bf16 v[52:67], v[36:39], v[220:223], v[52:67]
    v_mfma_f32_32x32x16_bf16 v[68:83], v[40:43], v[220:223], v[68:83]
    ds_read_b128 v[36:39], v9 offset:32768
    ds_read_b128 v[40:43], v9 offset:36864
    s_waitcnt lgkmcnt(4)
    v_mfma_f32_32x32x16_bf16 v[52:67], v[44:47], v[224:227], v[52:67]
    v_mfma_f32_32x32x16_bf16 v[68:83], v[48:51], v[224:227], v[68:83]
    ds_read_b128 v[44:47], v10 offset:32768
    ds_read_b128 v[48:51], v10 offset:36864
    s_waitcnt lgkmcnt(4)
    v_mfma_f32_32x32x16_bf16 v[52:67], v[28:31], v[228:231], v[52:67]
    v_mfma_f32_32x32x16_bf16 v[68:83], v[32:35], v[228:231], v[68:83]
    ds_read_b128 v[28:31], v11 offset:32768
    ds_read_b128 v[32:35], v11 offset:36864
    s_waitcnt lgkmcnt(4)
    v_mfma_f32_32x32x16_bf16 v[52:67], v[36:39], v[232:235], v[52:67]
    v_mfma_f32_32x32x16_bf16 v[68:83], v[40:43], v[232:235], v[68:83]
    s_waitcnt lgkmcnt(2)
    v_mfma_f32_32x32x16_bf16 v[52:67], v[44:47], v[236:239], v[52:67]
    v_mfma_f32_32x32x16_bf16 v[68:83], v[48:51], v[236:239], v[68:83]
    s_waitcnt lgkmcnt(0)
    v_mfma_f32_32x32x16_bf16 v[52:67], v[28:31], v[240:243], v[52:67]
    v_mfma_f32_32x32x16_bf16 v[68:83], v[32:35], v[240:243], v[68:83]
    v_lshrrev_b32 v3, 5, v1
    v_lshlrev_b32 v3, 5, v3
    v_add_u32 v3, 81920, v3
    s_lshl_b32 s22, s17, 7
    s_add_u32 s22, s22, 0
    s_barrier
    ds_read_b128 v[84:87], v3 offset:0
    ds_read_b128 v[88:91], v3 offset:16
    ds_read_b128 v[92:95], v3 offset:64
    ds_read_b128 v[96:99], v3 offset:80
    ds_read_b128 v[100:103], v3 offset:128
    ds_read_b128 v[104:107], v3 offset:144
    ds_read_b128 v[108:111], v3 offset:192
    ds_read_b128 v[112:115], v3 offset:208
    v_and_b32 v164, 31, v1
    v_lshrrev_b32 v165, 5, v1
    v_and_b32 v166, 7, v1
    v_xor_b32 v165, v165, v166
    v_lshlrev_b32 v165, 4, v165
    v_lshl_add_u32 v164, v164, 7, v165
    s_lshl_b32 s23, s16, 12
    v_add_u32 v164, s23, v164
    v_lshrrev_b32 v169, 3, v1
    v_xor_b32 v168, v169, v166
    v_lshlrev_b32 v168, 4, v168
    v_lshl_add_u32 v168, v169, 7, v168
    v_add_u32 v168, s23, v168
    v_xor_b32 v165, 32, v164
    v_xor_b32 v166, 64, v164
    v_xor_b32 v167, 96, v164
    s_lshl_b32 s23, s18, 2
    s_add_u32 s23, s23, s16
    s_lshl_b32 s23, s23, 4
    v_add_u32 v169, s23, v169
    v_lshlrev_b32 v169, 13, v169
    v_and_b32 v170, 7, v1
    v_lshl_add_u32 v169, v170, 4, v169
    s_waitcnt lgkmcnt(6)
    v_pk_mul_f32 v[52:53], v[52:53], v[84:85]
    v_pk_mul_f32 v[54:55], v[54:55], v[86:87]
    v_pk_mul_f32 v[56:57], v[56:57], v[88:89]
    v_pk_mul_f32 v[58:59], v[58:59], v[90:91]
    v_cvt_pk_bf16_f32 v116, v52, v53
    v_cvt_pk_bf16_f32 v117, v54, v55
    v_cvt_pk_bf16_f32 v118, v56, v57
    v_cvt_pk_bf16_f32 v119, v58, v59
    ds_write_b128 v164, v[116:119]
    s_waitcnt lgkmcnt(4)
    v_pk_mul_f32 v[60:61], v[60:61], v[92:93]
    v_pk_mul_f32 v[62:63], v[62:63], v[94:95]
    v_pk_mul_f32 v[64:65], v[64:65], v[96:97]
    v_pk_mul_f32 v[66:67], v[66:67], v[98:99]
    v_cvt_pk_bf16_f32 v120, v60, v61
    v_cvt_pk_bf16_f32 v121, v62, v63
    v_cvt_pk_bf16_f32 v122, v64, v65
    v_cvt_pk_bf16_f32 v123, v66, v67
    ds_write_b128 v165, v[120:123]
    s_waitcnt lgkmcnt(2)
    v_pk_mul_f32 v[68:69], v[68:69], v[100:101]
    v_pk_mul_f32 v[70:71], v[70:71], v[102:103]
    v_pk_mul_f32 v[72:73], v[72:73], v[104:105]
    v_pk_mul_f32 v[74:75], v[74:75], v[106:107]
    v_cvt_pk_bf16_f32 v124, v68, v69
    v_cvt_pk_bf16_f32 v125, v70, v71
    v_cvt_pk_bf16_f32 v126, v72, v73
    v_cvt_pk_bf16_f32 v127, v74, v75
    ds_write_b128 v166, v[124:127]
    s_waitcnt lgkmcnt(0)
    v_pk_mul_f32 v[76:77], v[76:77], v[108:109]
    v_pk_mul_f32 v[78:79], v[78:79], v[110:111]
    v_pk_mul_f32 v[80:81], v[80:81], v[112:113]
    v_pk_mul_f32 v[82:83], v[82:83], v[114:115]
    v_cvt_pk_bf16_f32 v128, v76, v77
    v_cvt_pk_bf16_f32 v129, v78, v79
    v_cvt_pk_bf16_f32 v130, v80, v81
    v_cvt_pk_bf16_f32 v131, v82, v83
    ds_write_b128 v167, v[128:131]
    s_waitcnt lgkmcnt(0)
    ds_read_b128 v[132:135], v168 offset:0
    ds_read_b128 v[136:139], v168 offset:1024
    ds_read_b128 v[140:143], v168 offset:2048
    ds_read_b128 v[144:147], v168 offset:3072
    s_add_u32 s23, s22, 0
    s_waitcnt lgkmcnt(3)
    buffer_store_dwordx4 v[132:135], v169, s[12:15], s23 offen sc1
    s_add_u32 s23, s22, 65536
    s_waitcnt lgkmcnt(2)
    buffer_store_dwordx4 v[136:139], v169, s[12:15], s23 offen sc1
    s_add_u32 s23, s22, 4096
    s_waitcnt lgkmcnt(1)
    buffer_store_dwordx4 v[140:143], v169, s[12:15], s23 offen sc1
    s_add_u32 s23, s22, 69632
    s_waitcnt lgkmcnt(0)
    buffer_store_dwordx4 v[144:147], v169, s[12:15], s23 offen sc1
    s_lshl_b32 s40, s18, 2
    s_add_u32 s40, s40, s16
    s_lshl_b32 s40, s40, 5
    s_add_u32 s40, s40, s17
    s_lshl_b32 s40, s40, 7
    s_add_u32 s40, s40, 24379392
    s_waitcnt vmcnt(0)
    v_readfirstlane_b32 s46, v2
    s_cmp_lg_u32 s46, 0
    s_cbranch_scc1 k1_kernel_have2
    s_mov_b32 s47, 20000
k1_kernel_nlp3:
    buffer_load_dword v2, off, s[36:39], 0 sc1
    s_waitcnt vmcnt(0)
    v_readfirstlane_b32 s46, v2
    s_sub_u32 s47, s47, 1
    s_cmp_eq_u32 s47, 0
    s_cbranch_scc1 k1_kernel_ndn4
    s_cmp_eq_u32 s46, 0
    s_cbranch_scc1 k1_kernel_nlp3
k1_kernel_ndn4:
k1_kernel_have2:
    v_mov_b32 v2, s46
    s_mov_b64 exec, 1
    buffer_store_dword v2, off, s[12:15], s40 sc1
    s_mov_b64 exec, -1
    s_branch k1_kernel_k2e
k1_kernel_prod:
    v_lshrrev_b32 v2, 3, v1
    v_mul_u32_u24 v2, 1280, v2
    v_lshrrev_b32 v3, 4, v1
    v_xor_b32 v3, v3, v1
    v_and_b32 v3, 7, v3
    v_lshl_add_u32 v4, v3, 4, v2
    v_xor_b32 v5, 64, v4
    v_add_u32 v5, 10240, v5
    s_lshl_b32 s22, s17, 2
    s_add_u32 s22, s22, s16
    s_mul_i32 s19, s22, 20480
    s_lshl_b32 s20, s16, 11
    s_waitcnt lgkmcnt(0)
    s_mov_b32 s8, s4
    s_mov_b32 s9, s5
    s_mov_b32 s10, 2621440
    s_mov_b32 s11, 0x00020000
    s_mov_b32 s12, s6
    s_mov_b32 s13, s7
    s_mov_b32 s14, 24772608
    s_mov_b32 s15, 0x00020000
    s_add_u32 m0, s20, 0
    s_add_u32 s22, s19, 0
    buffer_load_dwordx4 v4, s[8:11], s22 offen lds
    s_add_u32 m0, s20, 1024
    s_add_u32 s22, s19, 0
    buffer_load_dwordx4 v5, s[8:11], s22 offen lds
    s_add_u32 m0, s20, 40960
    s_add_u32 s22, s19, 640
    buffer_load_dwordx4 v4, s[8:11], s22 offen lds
    s_add_u32 m0, s20, 41984
    s_add_u32 s22, s19, 640
    buffer_load_dwordx4 v5, s[8:11], s22 offen lds
    s_add_u32 m0, s20, 8192
    s_add_u32 s22, s19, 128
    buffer_load_dwordx4 v4, s[8:11], s22 offen lds
    s_add_u32 m0, s20, 9216
    s_add_u32 s22, s19, 128
    buffer_load_dwordx4 v5, s[8:11], s22 offen lds
    s_add_u32 m0, s20, 49152
    s_add_u32 s22, s19, 768
    buffer_load_dwordx4 v4, s[8:11], s22 offen lds
    s_add_u32 m0, s20, 50176
    s_add_u32 s22, s19, 768
    buffer_load_dwordx4 v5, s[8:11], s22 offen lds
    s_add_u32 m0, s20, 16384
    s_add_u32 s22, s19, 256
    buffer_load_dwordx4 v4, s[8:11], s22 offen lds
    s_add_u32 m0, s20, 17408
    s_add_u32 s22, s19, 256
    buffer_load_dwordx4 v5, s[8:11], s22 offen lds
    s_add_u32 m0, s20, 57344
    s_add_u32 s22, s19, 896
    buffer_load_dwordx4 v4, s[8:11], s22 offen lds
    s_add_u32 m0, s20, 58368
    s_add_u32 s22, s19, 896
    buffer_load_dwordx4 v5, s[8:11], s22 offen lds
    s_add_u32 m0, s20, 24576
    s_add_u32 s22, s19, 384
    buffer_load_dwordx4 v4, s[8:11], s22 offen lds
    s_add_u32 m0, s20, 25600
    s_add_u32 s22, s19, 384
    buffer_load_dwordx4 v5, s[8:11], s22 offen lds
    s_add_u32 m0, s20, 65536
    s_add_u32 s22, s19, 1024
    buffer_load_dwordx4 v4, s[8:11], s22 offen lds
    s_add_u32 m0, s20, 66560
    s_add_u32 s22, s19, 1024
    buffer_load_dwordx4 v5, s[8:11], s22 offen lds
    s_add_u32 m0, s20, 32768
    s_add_u32 s22, s19, 512
    buffer_load_dwordx4 v4, s[8:11], s22 offen lds
    s_add_u32 m0, s20, 33792
    s_add_u32 s22, s19, 512
    buffer_load_dwordx4 v5, s[8:11], s22 offen lds
    s_add_u32 m0, s20, 73728
    s_add_u32 s22, s19, 1152
    buffer_load_dwordx4 v4, s[8:11], s22 offen lds
    s_add_u32 m0, s20, 74752
    s_add_u32 s22, s19, 1152
    buffer_load_dwordx4 v5, s[8:11], s22 offen lds
    v_mov_b32 v8, 0
    v_mov_b32 v9, 0
    v_mov_b32 v10, 0
    v_mov_b32 v11, 0
    v_mov_b32 v12, 0
    v_mov_b32 v13, 0
    v_mov_b32 v14, 0
    v_mov_b32 v15, 0
    v_lshlrev_b32 v6, 4, v1
    v_add_u32 v6, s20, v6
    v_add_u32 v7, 40960, v6
    s_mov_b32 s21, 0xffff0000
    s_waitcnt vmcnt(16)
    s_barrier
    ds_read_b128 v[16:19], v6 offset:0
    ds_read_b128 v[20:23], v6 offset:1024
    ds_read_b128 v[24:27], v7 offset:0
    s_waitcnt lgkmcnt(2)
    v_lshlrev_b32 v32, 16, v16
    v_and_b32 v33, s21, v16
    v_add_f32 v8, v8, v32
    v_fmac_f32 v10, v32, v32
    v_add_f32 v9, v9, v33
    v_fmac_f32 v11, v33, v33
    v_lshlrev_b32 v34, 16, v17
    v_and_b32 v35, s21, v17
    v_add_f32 v8, v8, v34
    v_fmac_f32 v10, v34, v34
    v_add_f32 v9, v9, v35
    v_fmac_f32 v11, v35, v35
    v_lshlrev_b32 v32, 16, v18
    v_and_b32 v33, s21, v18
    v_add_f32 v8, v8, v32
    v_fmac_f32 v10, v32, v32
    v_add_f32 v9, v9, v33
    v_fmac_f32 v11, v33, v33
    v_lshlrev_b32 v34, 16, v19
    v_and_b32 v35, s21, v19
    v_add_f32 v8, v8, v34
    v_fmac_f32 v10, v34, v34
    v_add_f32 v9, v9, v35
    v_fmac_f32 v11, v35, v35
    s_waitcnt lgkmcnt(1)
    v_lshlrev_b32 v32, 16, v20
    v_and_b32 v33, s21, v20
    v_add_f32 v12, v12, v32
    v_fmac_f32 v14, v32, v32
    v_add_f32 v13, v13, v33
    v_fmac_f32 v15, v33, v33
    v_lshlrev_b32 v34, 16, v21
    v_and_b32 v35, s21, v21
    v_add_f32 v12, v12, v34
    v_fmac_f32 v14, v34, v34
    v_add_f32 v13, v13, v35
    v_fmac_f32 v15, v35, v35
    v_lshlrev_b32 v32, 16, v22
    v_and_b32 v33, s21, v22
    v_add_f32 v12, v12, v32
    v_fmac_f32 v14, v32, v32
    v_add_f32 v13, v13, v33
    v_fmac_f32 v15, v33, v33
    v_lshlrev_b32 v34, 16, v23
    v_and_b32 v35, s21, v23
    v_add_f32 v12, v12, v34
    v_fmac_f32 v14, v34, v34
    v_add_f32 v13, v13, v35
    v_fmac_f32 v15, v35, v35
    s_waitcnt lgkmcnt(0)
    v_lshlrev_b32 v32, 16, v24
    v_and_b32 v33, s21, v24
    v_add_f32 v8, v8, v32
    v_fmac_f32 v10, v32, v32
    v_add_f32 v9, v9, v33
    v_fmac_f32 v11, v33, v33
    v_lshlrev_b32 v34, 16, v25
    v_and_b32 v35, s21, v25
    v_add_f32 v8, v8, v34
    v_fmac_f32 v10, v34, v34
    v_add_f32 v9, v9, v35
    v_fmac_f32 v11, v35, v35
    v_lshlrev_b32 v32, 16, v26
    v_and_b32 v33, s21, v26
    v_add_f32 v8, v8, v32
    v_fmac_f32 v10, v32, v32
    v_add_f32 v9, v9, v33
    v_fmac_f32 v11, v33, v33
    v_lshlrev_b32 v34, 16, v27
    v_and_b32 v35, s21, v27
    v_add_f32 v8, v8, v34
    v_fmac_f32 v10, v34, v34
    v_add_f32 v9, v9, v35
    v_fmac_f32 v11, v35, v35
    s_waitcnt vmcnt(12)
    s_barrier
    ds_read_b128 v[28:31], v7 offset:1024
    ds_read_b128 v[16:19], v6 offset:8192
    ds_read_b128 v[20:23], v6 offset:9216
    ds_read_b128 v[24:27], v7 offset:8192
    s_waitcnt lgkmcnt(3)
    v_lshlrev_b32 v32, 16, v28
    v_and_b32 v33, s21, v28
    v_add_f32 v12, v12, v32
    v_fmac_f32 v14, v32, v32
    v_add_f32 v13, v13, v33
    v_fmac_f32 v15, v33, v33
    v_lshlrev_b32 v34, 16, v29
    v_and_b32 v35, s21, v29
    v_add_f32 v12, v12, v34
    v_fmac_f32 v14, v34, v34
    v_add_f32 v13, v13, v35
    v_fmac_f32 v15, v35, v35
    v_lshlrev_b32 v32, 16, v30
    v_and_b32 v33, s21, v30
    v_add_f32 v12, v12, v32
    v_fmac_f32 v14, v32, v32
    v_add_f32 v13, v13, v33
    v_fmac_f32 v15, v33, v33
    v_lshlrev_b32 v34, 16, v31
    v_and_b32 v35, s21, v31
    v_add_f32 v12, v12, v34
    v_fmac_f32 v14, v34, v34
    v_add_f32 v13, v13, v35
    v_fmac_f32 v15, v35, v35
    s_waitcnt lgkmcnt(2)
    v_lshlrev_b32 v32, 16, v16
    v_and_b32 v33, s21, v16
    v_add_f32 v8, v8, v32
    v_fmac_f32 v10, v32, v32
    v_add_f32 v9, v9, v33
    v_fmac_f32 v11, v33, v33
    v_lshlrev_b32 v34, 16, v17
    v_and_b32 v35, s21, v17
    v_add_f32 v8, v8, v34
    v_fmac_f32 v10, v34, v34
    v_add_f32 v9, v9, v35
    v_fmac_f32 v11, v35, v35
    v_lshlrev_b32 v32, 16, v18
    v_and_b32 v33, s21, v18
    v_add_f32 v8, v8, v32
    v_fmac_f32 v10, v32, v32
    v_add_f32 v9, v9, v33
    v_fmac_f32 v11, v33, v33
    v_lshlrev_b32 v34, 16, v19
    v_and_b32 v35, s21, v19
    v_add_f32 v8, v8, v34
    v_fmac_f32 v10, v34, v34
    v_add_f32 v9, v9, v35
    v_fmac_f32 v11, v35, v35
    s_waitcnt lgkmcnt(1)
    v_lshlrev_b32 v32, 16, v20
    v_and_b32 v33, s21, v20
    v_add_f32 v12, v12, v32
    v_fmac_f32 v14, v32, v32
    v_add_f32 v13, v13, v33
    v_fmac_f32 v15, v33, v33
    v_lshlrev_b32 v34, 16, v21
    v_and_b32 v35, s21, v21
    v_add_f32 v12, v12, v34
    v_fmac_f32 v14, v34, v34
    v_add_f32 v13, v13, v35
    v_fmac_f32 v15, v35, v35
    v_lshlrev_b32 v32, 16, v22
    v_and_b32 v33, s21, v22
    v_add_f32 v12, v12, v32
    v_fmac_f32 v14, v32, v32
    v_add_f32 v13, v13, v33
    v_fmac_f32 v15, v33, v33
    v_lshlrev_b32 v34, 16, v23
    v_and_b32 v35, s21, v23
    v_add_f32 v12, v12, v34
    v_fmac_f32 v14, v34, v34
    v_add_f32 v13, v13, v35
    v_fmac_f32 v15, v35, v35
    s_waitcnt lgkmcnt(0)
    v_lshlrev_b32 v32, 16, v24
    v_and_b32 v33, s21, v24
    v_add_f32 v8, v8, v32
    v_fmac_f32 v10, v32, v32
    v_add_f32 v9, v9, v33
    v_fmac_f32 v11, v33, v33
    v_lshlrev_b32 v34, 16, v25
    v_and_b32 v35, s21, v25
    v_add_f32 v8, v8, v34
    v_fmac_f32 v10, v34, v34
    v_add_f32 v9, v9, v35
    v_fmac_f32 v11, v35, v35
    v_lshlrev_b32 v32, 16, v26
    v_and_b32 v33, s21, v26
    v_add_f32 v8, v8, v32
    v_fmac_f32 v10, v32, v32
    v_add_f32 v9, v9, v33
    v_fmac_f32 v11, v33, v33
    v_lshlrev_b32 v34, 16, v27
    v_and_b32 v35, s21, v27
    v_add_f32 v8, v8, v34
    v_fmac_f32 v10, v34, v34
    v_add_f32 v9, v9, v35
    v_fmac_f32 v11, v35, v35
    s_waitcnt vmcnt(8)
    s_barrier
    ds_read_b128 v[28:31], v7 offset:9216
    ds_read_b128 v[16:19], v6 offset:16384
    ds_read_b128 v[20:23], v6 offset:17408
    ds_read_b128 v[24:27], v7 offset:16384
    s_waitcnt lgkmcnt(3)
    v_lshlrev_b32 v32, 16, v28
    v_and_b32 v33, s21, v28
    v_add_f32 v12, v12, v32
    v_fmac_f32 v14, v32, v32
    v_add_f32 v13, v13, v33
    v_fmac_f32 v15, v33, v33
    v_lshlrev_b32 v34, 16, v29
    v_and_b32 v35, s21, v29
    v_add_f32 v12, v12, v34
    v_fmac_f32 v14, v34, v34
    v_add_f32 v13, v13, v35
    v_fmac_f32 v15, v35, v35
    v_lshlrev_b32 v32, 16, v30
    v_and_b32 v33, s21, v30
    v_add_f32 v12, v12, v32
    v_fmac_f32 v14, v32, v32
    v_add_f32 v13, v13, v33
    v_fmac_f32 v15, v33, v33
    v_lshlrev_b32 v34, 16, v31
    v_and_b32 v35, s21, v31
    v_add_f32 v12, v12, v34
    v_fmac_f32 v14, v34, v34
    v_add_f32 v13, v13, v35
    v_fmac_f32 v15, v35, v35
    s_waitcnt lgkmcnt(2)
    v_lshlrev_b32 v32, 16, v16
    v_and_b32 v33, s21, v16
    v_add_f32 v8, v8, v32
    v_fmac_f32 v10, v32, v32
    v_add_f32 v9, v9, v33
    v_fmac_f32 v11, v33, v33
    v_lshlrev_b32 v34, 16, v17
    v_and_b32 v35, s21, v17
    v_add_f32 v8, v8, v34
    v_fmac_f32 v10, v34, v34
    v_add_f32 v9, v9, v35
    v_fmac_f32 v11, v35, v35
    v_lshlrev_b32 v32, 16, v18
    v_and_b32 v33, s21, v18
    v_add_f32 v8, v8, v32
    v_fmac_f32 v10, v32, v32
    v_add_f32 v9, v9, v33
    v_fmac_f32 v11, v33, v33
    v_lshlrev_b32 v34, 16, v19
    v_and_b32 v35, s21, v19
    v_add_f32 v8, v8, v34
    v_fmac_f32 v10, v34, v34
    v_add_f32 v9, v9, v35
    v_fmac_f32 v11, v35, v35
    s_waitcnt lgkmcnt(1)
    v_lshlrev_b32 v32, 16, v20
    v_and_b32 v33, s21, v20
    v_add_f32 v12, v12, v32
    v_fmac_f32 v14, v32, v32
    v_add_f32 v13, v13, v33
    v_fmac_f32 v15, v33, v33
    v_lshlrev_b32 v34, 16, v21
    v_and_b32 v35, s21, v21
    v_add_f32 v12, v12, v34
    v_fmac_f32 v14, v34, v34
    v_add_f32 v13, v13, v35
    v_fmac_f32 v15, v35, v35
    v_lshlrev_b32 v32, 16, v22
    v_and_b32 v33, s21, v22
    v_add_f32 v12, v12, v32
    v_fmac_f32 v14, v32, v32
    v_add_f32 v13, v13, v33
    v_fmac_f32 v15, v33, v33
    v_lshlrev_b32 v34, 16, v23
    v_and_b32 v35, s21, v23
    v_add_f32 v12, v12, v34
    v_fmac_f32 v14, v34, v34
    v_add_f32 v13, v13, v35
    v_fmac_f32 v15, v35, v35
    s_waitcnt lgkmcnt(0)
    v_lshlrev_b32 v32, 16, v24
    v_and_b32 v33, s21, v24
    v_add_f32 v8, v8, v32
    v_fmac_f32 v10, v32, v32
    v_add_f32 v9, v9, v33
    v_fmac_f32 v11, v33, v33
    v_lshlrev_b32 v34, 16, v25
    v_and_b32 v35, s21, v25
    v_add_f32 v8, v8, v34
    v_fmac_f32 v10, v34, v34
    v_add_f32 v9, v9, v35
    v_fmac_f32 v11, v35, v35
    v_lshlrev_b32 v32, 16, v26
    v_and_b32 v33, s21, v26
    v_add_f32 v8, v8, v32
    v_fmac_f32 v10, v32, v32
    v_add_f32 v9, v9, v33
    v_fmac_f32 v11, v33, v33
    v_lshlrev_b32 v34, 16, v27
    v_and_b32 v35, s21, v27
    v_add_f32 v8, v8, v34
    v_fmac_f32 v10, v34, v34
    v_add_f32 v9, v9, v35
    v_fmac_f32 v11, v35, v35
    s_waitcnt vmcnt(4)
    s_barrier
    ds_read_b128 v[28:31], v7 offset:17408
    ds_read_b128 v[16:19], v6 offset:24576
    ds_read_b128 v[20:23], v6 offset:25600
    ds_read_b128 v[24:27], v7 offset:24576
    s_waitcnt lgkmcnt(3)
    v_lshlrev_b32 v32, 16, v28
    v_and_b32 v33, s21, v28
    v_add_f32 v12, v12, v32
    v_fmac_f32 v14, v32, v32
    v_add_f32 v13, v13, v33
    v_fmac_f32 v15, v33, v33
    v_lshlrev_b32 v34, 16, v29
    v_and_b32 v35, s21, v29
    v_add_f32 v12, v12, v34
    v_fmac_f32 v14, v34, v34
    v_add_f32 v13, v13, v35
    v_fmac_f32 v15, v35, v35
    v_lshlrev_b32 v32, 16, v30
    v_and_b32 v33, s21, v30
    v_add_f32 v12, v12, v32
    v_fmac_f32 v14, v32, v32
    v_add_f32 v13, v13, v33
    v_fmac_f32 v15, v33, v33
    v_lshlrev_b32 v34, 16, v31
    v_and_b32 v35, s21, v31
    v_add_f32 v12, v12, v34
    v_fmac_f32 v14, v34, v34
    v_add_f32 v13, v13, v35
    v_fmac_f32 v15, v35, v35
    s_waitcnt lgkmcnt(2)
    v_lshlrev_b32 v32, 16, v16
    v_and_b32 v33, s21, v16
    v_add_f32 v8, v8, v32
    v_fmac_f32 v10, v32, v32
    v_add_f32 v9, v9, v33
    v_fmac_f32 v11, v33, v33
    v_lshlrev_b32 v34, 16, v17
    v_and_b32 v35, s21, v17
    v_add_f32 v8, v8, v34
    v_fmac_f32 v10, v34, v34
    v_add_f32 v9, v9, v35
    v_fmac_f32 v11, v35, v35
    v_lshlrev_b32 v32, 16, v18
    v_and_b32 v33, s21, v18
    v_add_f32 v8, v8, v32
    v_fmac_f32 v10, v32, v32
    v_add_f32 v9, v9, v33
    v_fmac_f32 v11, v33, v33
    v_lshlrev_b32 v34, 16, v19
    v_and_b32 v35, s21, v19
    v_add_f32 v8, v8, v34
    v_fmac_f32 v10, v34, v34
    v_add_f32 v9, v9, v35
    v_fmac_f32 v11, v35, v35
    s_waitcnt lgkmcnt(1)
    v_lshlrev_b32 v32, 16, v20
    v_and_b32 v33, s21, v20
    v_add_f32 v12, v12, v32
    v_fmac_f32 v14, v32, v32
    v_add_f32 v13, v13, v33
    v_fmac_f32 v15, v33, v33
    v_lshlrev_b32 v34, 16, v21
    v_and_b32 v35, s21, v21
    v_add_f32 v12, v12, v34
    v_fmac_f32 v14, v34, v34
    v_add_f32 v13, v13, v35
    v_fmac_f32 v15, v35, v35
    v_lshlrev_b32 v32, 16, v22
    v_and_b32 v33, s21, v22
    v_add_f32 v12, v12, v32
    v_fmac_f32 v14, v32, v32
    v_add_f32 v13, v13, v33
    v_fmac_f32 v15, v33, v33
    v_lshlrev_b32 v34, 16, v23
    v_and_b32 v35, s21, v23
    v_add_f32 v12, v12, v34
    v_fmac_f32 v14, v34, v34
    v_add_f32 v13, v13, v35
    v_fmac_f32 v15, v35, v35
    s_waitcnt lgkmcnt(0)
    v_lshlrev_b32 v32, 16, v24
    v_and_b32 v33, s21, v24
    v_add_f32 v8, v8, v32
    v_fmac_f32 v10, v32, v32
    v_add_f32 v9, v9, v33
    v_fmac_f32 v11, v33, v33
    v_lshlrev_b32 v34, 16, v25
    v_and_b32 v35, s21, v25
    v_add_f32 v8, v8, v34
    v_fmac_f32 v10, v34, v34
    v_add_f32 v9, v9, v35
    v_fmac_f32 v11, v35, v35
    v_lshlrev_b32 v32, 16, v26
    v_and_b32 v33, s21, v26
    v_add_f32 v8, v8, v32
    v_fmac_f32 v10, v32, v32
    v_add_f32 v9, v9, v33
    v_fmac_f32 v11, v33, v33
    v_lshlrev_b32 v34, 16, v27
    v_and_b32 v35, s21, v27
    v_add_f32 v8, v8, v34
    v_fmac_f32 v10, v34, v34
    v_add_f32 v9, v9, v35
    v_fmac_f32 v11, v35, v35
    s_waitcnt vmcnt(0)
    s_barrier
    ds_read_b128 v[28:31], v7 offset:25600
    ds_read_b128 v[16:19], v6 offset:32768
    ds_read_b128 v[20:23], v6 offset:33792
    ds_read_b128 v[24:27], v7 offset:32768
    s_waitcnt lgkmcnt(3)
    v_lshlrev_b32 v32, 16, v28
    v_and_b32 v33, s21, v28
    v_add_f32 v12, v12, v32
    v_fmac_f32 v14, v32, v32
    v_add_f32 v13, v13, v33
    v_fmac_f32 v15, v33, v33
    v_lshlrev_b32 v34, 16, v29
    v_and_b32 v35, s21, v29
    v_add_f32 v12, v12, v34
    v_fmac_f32 v14, v34, v34
    v_add_f32 v13, v13, v35
    v_fmac_f32 v15, v35, v35
    v_lshlrev_b32 v32, 16, v30
    v_and_b32 v33, s21, v30
    v_add_f32 v12, v12, v32
    v_fmac_f32 v14, v32, v32
    v_add_f32 v13, v13, v33
    v_fmac_f32 v15, v33, v33
    v_lshlrev_b32 v34, 16, v31
    v_and_b32 v35, s21, v31
    v_add_f32 v12, v12, v34
    v_fmac_f32 v14, v34, v34
    v_add_f32 v13, v13, v35
    v_fmac_f32 v15, v35, v35
    ds_read_b128 v[28:31], v7 offset:33792
    s_waitcnt lgkmcnt(3)
    v_lshlrev_b32 v32, 16, v16
    v_and_b32 v33, s21, v16
    v_add_f32 v8, v8, v32
    v_fmac_f32 v10, v32, v32
    v_add_f32 v9, v9, v33
    v_fmac_f32 v11, v33, v33
    v_lshlrev_b32 v34, 16, v17
    v_and_b32 v35, s21, v17
    v_add_f32 v8, v8, v34
    v_fmac_f32 v10, v34, v34
    v_add_f32 v9, v9, v35
    v_fmac_f32 v11, v35, v35
    v_lshlrev_b32 v32, 16, v18
    v_and_b32 v33, s21, v18
    v_add_f32 v8, v8, v32
    v_fmac_f32 v10, v32, v32
    v_add_f32 v9, v9, v33
    v_fmac_f32 v11, v33, v33
    v_lshlrev_b32 v34, 16, v19
    v_and_b32 v35, s21, v19
    v_add_f32 v8, v8, v34
    v_fmac_f32 v10, v34, v34
    v_add_f32 v9, v9, v35
    v_fmac_f32 v11, v35, v35
    s_waitcnt lgkmcnt(2)
    v_lshlrev_b32 v32, 16, v20
    v_and_b32 v33, s21, v20
    v_add_f32 v12, v12, v32
    v_fmac_f32 v14, v32, v32
    v_add_f32 v13, v13, v33
    v_fmac_f32 v15, v33, v33
    v_lshlrev_b32 v34, 16, v21
    v_and_b32 v35, s21, v21
    v_add_f32 v12, v12, v34
    v_fmac_f32 v14, v34, v34
    v_add_f32 v13, v13, v35
    v_fmac_f32 v15, v35, v35
    v_lshlrev_b32 v32, 16, v22
    v_and_b32 v33, s21, v22
    v_add_f32 v12, v12, v32
    v_fmac_f32 v14, v32, v32
    v_add_f32 v13, v13, v33
    v_fmac_f32 v15, v33, v33
    v_lshlrev_b32 v34, 16, v23
    v_and_b32 v35, s21, v23
    v_add_f32 v12, v12, v34
    v_fmac_f32 v14, v34, v34
    v_add_f32 v13, v13, v35
    v_fmac_f32 v15, v35, v35
    s_waitcnt lgkmcnt(1)
    v_lshlrev_b32 v32, 16, v24
    v_and_b32 v33, s21, v24
    v_add_f32 v8, v8, v32
    v_fmac_f32 v10, v32, v32
    v_add_f32 v9, v9, v33
    v_fmac_f32 v11, v33, v33
    v_lshlrev_b32 v34, 16, v25
    v_and_b32 v35, s21, v25
    v_add_f32 v8, v8, v34
    v_fmac_f32 v10, v34, v34
    v_add_f32 v9, v9, v35
    v_fmac_f32 v11, v35, v35
    v_lshlrev_b32 v32, 16, v26
    v_and_b32 v33, s21, v26
    v_add_f32 v8, v8, v32
    v_fmac_f32 v10, v32, v32
    v_add_f32 v9, v9, v33
    v_fmac_f32 v11, v33, v33
    v_lshlrev_b32 v34, 16, v27
    v_and_b32 v35, s21, v27
    v_add_f32 v8, v8, v34
    v_fmac_f32 v10, v34, v34
    v_add_f32 v9, v9, v35
    v_fmac_f32 v11, v35, v35
    s_waitcnt lgkmcnt(0)
    v_lshlrev_b32 v32, 16, v28
    v_and_b32 v33, s21, v28
    v_add_f32 v12, v12, v32
    v_fmac_f32 v14, v32, v32
    v_add_f32 v13, v13, v33
    v_fmac_f32 v15, v33, v33
    v_lshlrev_b32 v34, 16, v29
    v_and_b32 v35, s21, v29
    v_add_f32 v12, v12, v34
    v_fmac_f32 v14, v34, v34
    v_add_f32 v13, v13, v35
    v_fmac_f32 v15, v35, v35
    v_lshlrev_b32 v32, 16, v30
    v_and_b32 v33, s21, v30
    v_add_f32 v12, v12, v32
    v_fmac_f32 v14, v32, v32
    v_add_f32 v13, v13, v33
    v_fmac_f32 v15, v33, v33
    v_lshlrev_b32 v34, 16, v31
    v_and_b32 v35, s21, v31
    v_add_f32 v12, v12, v34
    v_fmac_f32 v14, v34, v34
    v_add_f32 v13, v13, v35
    v_fmac_f32 v15, v35, v35
    v_add_f32 v36, v8, v9
    v_add_f32 v37, v10, v11
    v_add_f32 v38, v12, v13
    v_add_f32 v39, v14, v15
    s_nop 0
    v_add_f32_dpp v36, v36, v36 quad_perm:[1,0,3,2] row_mask:0xf bank_mask:0xf
    v_add_f32_dpp v37, v37, v37 quad_perm:[1,0,3,2] row_mask:0xf bank_mask:0xf
    v_add_f32_dpp v38, v38, v38 quad_perm:[1,0,3,2] row_mask:0xf bank_mask:0xf
    v_add_f32_dpp v39, v39, v39 quad_perm:[1,0,3,2] row_mask:0xf bank_mask:0xf
    s_nop 0
    v_add_f32_dpp v36, v36, v36 quad_perm:[2,3,0,1] row_mask:0xf bank_mask:0xf
    v_add_f32_dpp v37, v37, v37 quad_perm:[2,3,0,1] row_mask:0xf bank_mask:0xf
    v_add_f32_dpp v38, v38, v38 quad_perm:[2,3,0,1] row_mask:0xf bank_mask:0xf
    v_add_f32_dpp v39, v39, v39 quad_perm:[2,3,0,1] row_mask:0xf bank_mask:0xf
    s_nop 0
    v_add_f32_dpp v36, v36, v36 row_half_mirror row_mask:0xf bank_mask:0xf
    v_add_f32_dpp v37, v37, v37 row_half_mirror row_mask:0xf bank_mask:0xf
    v_add_f32_dpp v38, v38, v38 row_half_mirror row_mask:0xf bank_mask:0xf
    v_add_f32_dpp v39, v39, v39 row_half_mirror row_mask:0xf bank_mask:0xf
    v_and_b32 v3, 1, v1
    v_cmp_eq_u32 vcc, 1, v3
    v_lshrrev_b32 v40, 3, v1
    v_lshl_add_u32 v40, v3, 3, v40
    v_cndmask_b32 v36, v36, v38, vcc
    v_cndmask_b32 v37, v37, v39, vcc
    v_mul_f32 v36, 0x3acccccd, v36
    v_mul_f32 v38, v36, v36
    v_mul_f32 v37, 0x3acccccd, v37
    v_sub_f32 v37, v37, v38
    v_max_f32 v37, 0, v37
    v_add_f32 v37, 0x3727c5ac, v37
    v_rsq_f32 v37, v37
    s_lshl_b32 s22, s16, 4
    v_add_u32 v40, s22, v40
    v_lshlrev_b32 v40, 2, v40
    v_add_u32 v41, 81920, v40
    ds_write_b32 v41, v37
    s_cmp_lg_u32 s18, 0
    s_cbranch_scc1 k1_kernel_L5
    s_lshl_b32 s22, s17, 8
    s_add_u32 s22, s22, 16777216
    buffer_store_dword v36, v40, s[12:15], s22 offen sc1
k1_kernel_L5:
    s_waitcnt vmcnt(0)
    s_waitcnt lgkmcnt(0)
    s_barrier
k1_kernel_k2e:
    v_lshrrev_b32 v1, 6, v0
    s_nop 0
    v_readfirstlane_b32 s44, v1
    s_mov_b32 s36, s42
    s_mov_b32 s37, s43
    s_mov_b32 s38, 256
    s_mov_b32 s39, 0x00020000
    s_mov_b32 s12, s6
    s_mov_b32 s13, s7
    s_mov_b32 s14, 24772608
    s_mov_b32 s15, 0x00020000
    s_lshr_b32 s22, s44, 2
    s_sub_u32 s27, s2, 96
    s_lshl_b32 s27, s27, 1
    s_add_u32 s27, s27, s22
    s_lshl_b32 s45, s22, 14
    s_add_u32 s45, s45, 84992
    s_cmp_lt_u32 s44, 4
    s_cbranch_scc1 k1_kernel_cons6
    s_mov_b32 s47, 20000
k1_kernel_nlp7:
    buffer_load_dword v1, off, s[36:39], 0 sc1
    s_waitcnt vmcnt(0)
    v_readfirstlane_b32 s46, v1
    s_sub_u32 s47, s47, 1
    s_cmp_eq_u32 s47, 0
    s_cbranch_scc1 k1_kernel_ndn8
    s_cmp_eq_u32 s46, 0
    s_cbranch_scc1 k1_kernel_nlp7
k1_kernel_ndn8:
k1_kernel_cons6:
    v_and_b32 v1, 63, v0
    v_lshrrev_b32 v4, 6, v0
    v_and_b32 v4, 3, v4
    v_lshrrev_b32 v2, 4, v1
    v_readfirstlane_b32 s16, v4
    v_and_b32 v3, 15, v1
    v_lshrrev_b32 v5, 5, v1
    v_lshlrev_b32 v5, 1, v5
    v_xor_b32 v5, v5, v1
    v_lshlrev_b32 v5, 4, v5
    v_lshlrev_b32 v6, 4, v1
    s_lshl_b32 s17, s16, 11
    s_lshl_b32 s18, s27, 13
    s_add_u32 s19, s18, s17
    s_add_u32 s20, s19, 0
    s_add_u32 s21, s19, 2621440
    s_add_u32 s17, s17, s45
    s_mov_b32 m0, s17
    s_mov_b32 s8, s6
    s_mov_b32 s9, s7
    s_mov_b32 s10, 24772608
    s_mov_b32 s11, 0x00020000
    v_mov_b32 v168, v5
    v_mov_b32 v169, v6
    s_lshl_b32 s22, s16, 4
    v_add_u32 v4, s22, v3
    v_cvt_f32_u32 v22, v4
    v_cvt_f32_u32 v23, v2
    v_cvt_f32_u32 v24, v3
    v_lshlrev_b32 v4, 31, v3
    v_lshrrev_b32 v5, 16, v4
    v_or_b32 v4, v4, v5
    v_mul_f32 v25, 0x3c800000, v22
    v_mul_f32 v14, v22, v23
    v_mul_f32 v14, 0x3e000000, v14
    v_add_f32 v15, v14, v25
    v_add_f32 v16, v15, v25
    v_add_f32 v17, v16, v25
    v_add_f32 v18, v17, v25
    v_add_f32 v19, v18, v25
    v_add_f32 v20, v19, v25
    v_add_f32 v21, v20, v25
    v_cos_f32 v120, v14
    v_cos_f32 v121, v15
    v_cos_f32 v122, v16
    v_cos_f32 v123, v17
    v_cos_f32 v124, v18
    v_cos_f32 v125, v19
    v_cos_f32 v126, v20
    v_cos_f32 v127, v21
    v_sin_f32 v128, v14
    v_sin_f32 v129, v15
    v_sin_f32 v130, v16
    v_sin_f32 v131, v17
    v_sin_f32 v132, v18
    v_sin_f32 v133, v19
    v_sin_f32 v134, v20
    v_sin_f32 v135, v21
    v_cvt_pk_bf16_f32 v32, v120, v121
    v_cvt_pk_bf16_f32 v33, v122, v123
    v_cvt_pk_bf16_f32 v34, v124, v125
    v_cvt_pk_bf16_f32 v35, v126, v127
    v_cvt_pk_bf16_f32 v40, v128, v129
    v_cvt_pk_bf16_f32 v41, v130, v131
    v_cvt_pk_bf16_f32 v42, v132, v133
    v_cvt_pk_bf16_f32 v43, v134, v135
    s_mov_b32 s23, 0x80008000
    v_xor_b32 v36, v4, v32
    v_xor_b32 v44, v4, v40
    v_xor_b32 v37, v4, v33
    v_xor_b32 v45, v4, v41
    v_xor_b32 v38, v4, v34
    v_xor_b32 v46, v4, v42
    v_xor_b32 v39, v4, v35
    v_xor_b32 v47, v4, v43
    v_xor_b32 v48, s23, v40
    v_xor_b32 v49, s23, v41
    v_xor_b32 v50, s23, v42
    v_xor_b32 v51, s23, v43
    v_xor_b32 v52, s23, v44
    v_xor_b32 v53, s23, v45
    v_xor_b32 v54, s23, v46
    v_xor_b32 v55, s23, v47
    v_mul_f32 v25, 0x3d000000, v24
    v_mul_f32 v14, v24, v23
    v_mul_f32 v14, 0x3e000000, v14
    v_add_f32 v15, v14, v25
    v_add_f32 v16, v15, v25
    v_add_f32 v17, v16, v25
    v_cos_f32 v120, v14
    v_cos_f32 v121, v15
    v_cos_f32 v122, v16
    v_cos_f32 v123, v17
    v_sin_f32 v124, v14
    v_sin_f32 v125, v15
    v_sin_f32 v126, v16
    v_sin_f32 v127, v17
    s_nop 0
    v_cvt_pk_bf16_f32 v56, v120, v121
    v_cvt_pk_bf16_f32 v57, v122, v123
    v_cvt_pk_bf16_f32 v64, v124, v125
    v_cvt_pk_bf16_f32 v65, v126, v127
    v_xor_b32 v58, v4, v56
    v_xor_b32 v66, v4, v64
    v_xor_b32 v59, v4, v57
    v_xor_b32 v67, v4, v65
    s_brev_b32 s24, 1
    v_xor_b32 v60, s24, v56
    v_xor_b32 v68, s24, v64
    v_xor_b32 v61, s24, v57
    v_xor_b32 v69, s24, v65
    v_xor_b32 v62, s24, v58
    v_xor_b32 v70, s24, v66
    v_xor_b32 v63, s24, v59
    v_xor_b32 v71, s24, v67
    v_xor_b32 v72, s23, v64
    v_xor_b32 v73, s23, v65
    v_xor_b32 v74, s23, v66
    v_xor_b32 v75, s23, v67
    v_xor_b32 v76, s23, v68
    v_xor_b32 v77, s23, v69
    v_xor_b32 v78, s23, v70
    v_xor_b32 v79, s23, v71
    v_mul_f32 v25, 0x3a000000, v22
    v_mul_f32 v14, v25, v23
    v_mul_f32 v14, 4.0, v14
    v_add_f32 v15, v14, v25
    v_add_f32 v16, v15, v25
    v_add_f32 v17, v16, v25
    v_mul_f32 v26, 0x41800000, v25
    v_add_f32 v18, v14, v26
    v_add_f32 v19, v15, v26
    v_add_f32 v20, v16, v26
    v_add_f32 v21, v17, v26
    v_cos_f32 v80, v14
    v_cos_f32 v81, v15
    v_cos_f32 v82, v16
    v_cos_f32 v83, v17
    v_cos_f32 v84, v18
    v_cos_f32 v85, v19
    v_cos_f32 v86, v20
    v_cos_f32 v87, v21
    v_sin_f32 v88, v14
    v_sin_f32 v89, v15
    v_sin_f32 v90, v16
    v_sin_f32 v91, v17
    v_sin_f32 v92, v18
    v_sin_f32 v93, v19
    v_sin_f32 v94, v20
    v_sin_f32 v95, v21
    v_fma_f32 v27, v23, 4.0, v22
    v_sub_f32 v27, v27, v24
    v_mul_f32 v27, 0x3a000000, v27
    v_mul_f32 v25, 0x3a000000, v24
    v_mul_f32 v14, v27, v24
    v_add_f32 v15, v14, v25
    v_add_f32 v16, v15, v25
    v_add_f32 v17, v16, v25
    v_mul_f32 v26, 0x41800000, v27
    v_add_f32 v18, v14, v26
    v_add_f32 v26, 0x3c000000, v26
    v_add_f32 v19, v15, v26
    v_add_f32 v26, 0x3c000000, v26
    v_add_f32 v20, v16, v26
    v_add_f32 v26, 0x3c000000, v26
    v_add_f32 v21, v17, v26
    v_cos_f32 v96, v14
    v_cos_f32 v97, v15
    v_cos_f32 v98, v16
    v_cos_f32 v99, v17
    v_cos_f32 v100, v18
    v_cos_f32 v101, v19
    v_cos_f32 v102, v20
    v_cos_f32 v103, v21
    v_sin_f32 v104, v14
    v_sin_f32 v105, v15
    v_sin_f32 v106, v16
    v_sin_f32 v107, v17
    v_sin_f32 v108, v18
    v_sin_f32 v109, v19
    v_sin_f32 v110, v20
    v_sin_f32 v111, v21
    v_lshrrev_b32 v5, 2, v3
    v_lshlrev_b32 v5, 6, v5
    v_lshl_add_u32 v5, v2, 9, v5
    v_bfe_u32 v6, v3, 1, 1
    v_lshlrev_b32 v14, 1, v2
    v_and_b32 v14, 2, v14
    v_xor_b32 v6, v6, v14
    v_lshl_add_u32 v5, v6, 4, v5
    v_and_b32 v6, 1, v3
    v_lshl_add_u32 v7, v6, 3, v5
    v_add_u32 v7, s45, v7
    v_xor_b32 v8, 32, v7
    v_bfe_u32 v5, v3, 1, 1
    v_lshrrev_b32 v6, 3, v3
    v_lshl_or_b32 v5, v6, 1, v5
    v_lshrrev_b32 v6, 1, v2
    s_lshl_b32 s22, s16, 1
    v_add_u32 v6, s22, v6
    v_xor_b32 v5, v5, v6
    v_lshlrev_b32 v5, 4, v5
    v_lshl_add_u32 v5, v3, 7, v5
    v_and_b32 v6, 1, v2
    v_lshl_add_u32 v5, v6, 3, v5
    v_add_u32 v9, 8192, v5
    v_xor_b32 v5, 64, v5
    v_add_u32 v10, 10240, v5
    v_add_u32 v9, s45, v9
    v_add_u32 v10, s45, v10
    v_lshrrev_b32 v6, 2, v3
    v_bfe_u32 v5, v3, 1, 1
    v_lshl_or_b32 v5, v6, 1, v5
    v_xor_b32 v5, v5, v2
    v_lshlrev_b32 v5, 4, v5
    v_lshl_add_u32 v5, v6, 10, v5
    v_and_b32 v6, 3, v3
    v_lshl_add_u32 v5, v6, 7, v5
    v_add_u32 v11, 8192, v5
    v_add_u32 v11, s45, v11
    v_xor_b32 v12, 64, v11
    v_lshlrev_b32 v5, 6, v3
    v_lshl_add_u32 v13, v2, 4, v5
    s_lshl_b32 s22, s16, 10
    s_add_u32 s22, s22, s18
    s_add_u32 s25, s22, 5242880
    v_mov_b32 v152, 0
    v_mov_b32 v153, 0
    v_mov_b32 v154, 0
    v_mov_b32 v155, 0
    v_mov_b32 v156, 0
    v_mov_b32 v157, 0
    v_mov_b32 v158, 0
    v_mov_b32 v159, 0
    v_mov_b32 v160, 0
    v_mov_b32 v161, 0
    v_mov_b32 v162, 0
    v_mov_b32 v163, 0
    v_mov_b32 v164, 0
    v_mov_b32 v165, 0
    v_mov_b32 v166, 0
    v_mov_b32 v167, 0
    s_lshr_b32 s28, s27, 4
    s_lshl_b32 s28, s28, 5
    s_and_b32 s29, s16, 1
    s_lshl_b32 s29, s29, 4
    s_add_u32 s28, s28, s29
    s_lshr_b32 s29, s27, 5
    s_lshl_b32 s29, s29, 3
    s_lshl_b32 s30, s16, 1
    s_add_u32 s29, s29, s30
    s_lshl_b32 s29, s29, 2
    s_add_u32 s29, s29, 624
    v_add_u32 v5, s28, v1
    v_add_u32 v6, s29, v1
    v_cmp_gt_u32 vcc, 16, v1
    v_cndmask_b32 v5, v6, v5, vcc
    v_mov_b32 v6, s28
    v_cmp_gt_u32 vcc, 24, v1
    v_cndmask_b32 v5, v6, v5, vcc
    v_lshlrev_b32 v5, 7, v5
    s_mov_b32 s31, 24379392
    s_mov_b32 s47, 20000
k1_kernel_poll9:
    buffer_load_dword v6, v5, s[12:15], s31 offen sc1
    s_sub_u32 s47, s47, 1
    s_cmp_eq_u32 s47, 0
    s_cbranch_scc1 k1_kernel_got10
    s_waitcnt vmcnt(0)
    v_cmp_ne_u32 vcc, s46, v6
    s_cmp_lg_u64 vcc, 0
    s_cbranch_scc1 k1_kernel_poll9
k1_kernel_got10:
    s_waitcnt vmcnt(0)
    buffer_load_dwordx4 v168, s[8:11], s20 offen lds
    buffer_load_dwordx4 v168, s[8:11], s20 offen offset:1024 lds
    buffer_load_dwordx4 v[112:115], v169, s[8:11], s21 offen
    buffer_load_dwordx4 v[116:119], v169, s[8:11], s21 offen offset:1024
    v_mov_b32 v168, 0
    v_mov_b32 v169, 0
    v_mov_b32 v170, 0
    v_mov_b32 v171, 0
    v_mov_b32 v172, 0
    v_mov_b32 v173, 0
    v_mov_b32 v174, 0
    v_mov_b32 v175, 0
    v_mov_b32 v176, 0
    v_mov_b32 v177, 0
    v_mov_b32 v178, 0
    v_mov_b32 v179, 0
    v_mov_b32 v180, 0
    v_mov_b32 v181, 0
    v_mov_b32 v182, 0
    v_mov_b32 v183, 0
    s_waitcnt vmcnt(2)
    s_barrier
    ds_read_b64_tr_b16 v[120:121], v7 offset:0
    ds_read_b64_tr_b16 v[122:123], v7 offset:256
    ds_read_b64_tr_b16 v[128:129], v8 offset:0
    ds_read_b64_tr_b16 v[130:131], v8 offset:256
    ds_read_b64_tr_b16 v[136:137], v7 offset:4096
    ds_read_b64_tr_b16 v[138:139], v7 offset:4352
    ds_read_b64_tr_b16 v[144:145], v8 offset:4096
    ds_read_b64_tr_b16 v[146:147], v8 offset:4352
    ds_read_b64_tr_b16 v[124:125], v7 offset:2048
    ds_read_b64_tr_b16 v[126:127], v7 offset:2304
    ds_read_b64_tr_b16 v[132:133], v8 offset:2048
    ds_read_b64_tr_b16 v[134:135], v8 offset:2304
    ds_read_b64_tr_b16 v[140:141], v7 offset:6144
    ds_read_b64_tr_b16 v[142:143], v7 offset:6400
    ds_read_b64_tr_b16 v[148:149], v8 offset:6144
    ds_read_b64_tr_b16 v[150:151], v8 offset:6400
    s_waitcnt lgkmcnt(12)
    v_mfma_f32_16x16x32_bf16 v[152:155], v[120:123], v[32:35], v[152:155]
    v_mfma_f32_16x16x32_bf16 v[156:159], v[120:123], v[48:51], v[156:159]
    v_mfma_f32_16x16x32_bf16 v[160:163], v[128:131], v[32:35], v[160:163]
    v_mfma_f32_16x16x32_bf16 v[164:167], v[128:131], v[48:51], v[164:167]
    s_waitcnt lgkmcnt(8)
    v_mfma_f32_16x16x32_bf16 v[152:155], v[136:139], v[40:43], v[152:155]
    v_mfma_f32_16x16x32_bf16 v[156:159], v[136:139], v[32:35], v[156:159]
    v_mfma_f32_16x16x32_bf16 v[160:163], v[144:147], v[40:43], v[160:163]
    v_mfma_f32_16x16x32_bf16 v[164:167], v[144:147], v[32:35], v[164:167]
    s_waitcnt lgkmcnt(4)
    v_mfma_f32_16x16x32_bf16 v[152:155], v[124:127], v[36:39], v[152:155]
    v_mfma_f32_16x16x32_bf16 v[156:159], v[124:127], v[52:55], v[156:159]
    v_mfma_f32_16x16x32_bf16 v[160:163], v[132:135], v[36:39], v[160:163]
    v_mfma_f32_16x16x32_bf16 v[164:167], v[132:135], v[52:55], v[164:167]
    s_waitcnt lgkmcnt(0)
    v_mfma_f32_16x16x32_bf16 v[152:155], v[140:143], v[44:47], v[152:155]
    v_mfma_f32_16x16x32_bf16 v[156:159], v[140:143], v[36:39], v[156:159]
    v_mfma_f32_16x16x32_bf16 v[160:163], v[148:151], v[44:47], v[160:163]
    v_mfma_f32_16x16x32_bf16 v[164:167], v[148:151], v[36:39], v[164:167]
    s_nop 7
    v_pk_mul_f32 v[14:15], v[152:153], v[80:81]
    v_pk_mul_f32 v[16:17], v[156:157], v[80:81]
    v_pk_mul_f32 v[18:19], v[154:155], v[82:83]
    v_pk_mul_f32 v[20:21], v[158:159], v[82:83]
    v_pk_fma_f32 v[14:15], v[156:157], v[88:89], v[14:15]
    v_pk_fma_f32 v[16:17], v[152:153], v[88:89], v[16:17] neg_lo:[0,1,0] neg_hi:[0,1,0]
    v_pk_fma_f32 v[18:19], v[158:159], v[90:91], v[18:19]
    v_pk_fma_f32 v[20:21], v[154:155], v[90:91], v[20:21] neg_lo:[0,1,0] neg_hi:[0,1,0]
    v_cvt_pk_bf16_f32 v184, v14, v15
    v_cvt_pk_bf16_f32 v188, v16, v17
    v_cvt_pk_bf16_f32 v185, v18, v19
    v_cvt_pk_bf16_f32 v189, v20, v21
    v_pk_mul_f32 v[14:15], v[160:161], v[84:85]
    v_pk_mul_f32 v[16:17], v[164:165], v[84:85]
    v_pk_mul_f32 v[18:19], v[162:163], v[86:87]
    v_pk_mul_f32 v[20:21], v[166:167], v[86:87]
    v_pk_fma_f32 v[14:15], v[164:165], v[92:93], v[14:15]
    v_pk_fma_f32 v[16:17], v[160:161], v[92:93], v[16:17] neg_lo:[0,1,0] neg_hi:[0,1,0]
    v_pk_fma_f32 v[18:19], v[166:167], v[94:95], v[18:19]
    v_pk_fma_f32 v[20:21], v[162:163], v[94:95], v[20:21] neg_lo:[0,1,0] neg_hi:[0,1,0]
    v_cvt_pk_bf16_f32 v186, v14, v15
    v_cvt_pk_bf16_f32 v190, v16, v17
    v_cvt_pk_bf16_f32 v187, v18, v19
    v_cvt_pk_bf16_f32 v191, v20, v21
    s_nop 1
    v_mfma_f32_16x16x32_bf16 v[168:171], v[56:59], v[184:187], v[168:171]
    v_mfma_f32_16x16x32_bf16 v[172:175], v[56:59], v[188:191], v[172:175]
    v_mfma_f32_16x16x32_bf16 v[176:179], v[60:63], v[184:187], v[176:179]
    v_mfma_f32_16x16x32_bf16 v[180:183], v[60:63], v[188:191], v[180:183]
    v_mfma_f32_16x16x32_bf16 v[168:171], v[64:67], v[188:191], v[168:171]
    v_mfma_f32_16x16x32_bf16 v[172:175], v[72:75], v[184:187], v[172:175]
    v_mfma_f32_16x16x32_bf16 v[176:179], v[68:71], v[188:191], v[176:179]
    v_mfma_f32_16x16x32_bf16 v[180:183], v[76:79], v[184:187], v[180:183]
    s_waitcnt vmcnt(0)
    v_lshlrev_b32 v120, 16, v112
    v_and_b32 v128, 0xffff0000, v112
    v_lshlrev_b32 v121, 16, v113
    v_and_b32 v129, 0xffff0000, v113
    v_lshlrev_b32 v122, 16, v114
    v_and_b32 v130, 0xffff0000, v114
    v_lshlrev_b32 v123, 16, v115
    v_and_b32 v131, 0xffff0000, v115
    v_lshlrev_b32 v124, 16, v116
    v_and_b32 v132, 0xffff0000, v116
    v_lshlrev_b32 v125, 16, v117
    v_and_b32 v133, 0xffff0000, v117
    v_lshlrev_b32 v126, 16, v118
    v_and_b32 v134, 0xffff0000, v118
    v_lshlrev_b32 v127, 16, v119
    v_and_b32 v135, 0xffff0000, v119
    v_mov_b32 v152, 0
    v_mov_b32 v153, 0
    v_mov_b32 v154, 0
    v_mov_b32 v155, 0
    v_mov_b32 v156, 0
    v_mov_b32 v157, 0
    v_mov_b32 v158, 0
    v_mov_b32 v159, 0
    v_mov_b32 v160, 0
    v_mov_b32 v161, 0
    v_mov_b32 v162, 0
    v_mov_b32 v163, 0
    v_mov_b32 v164, 0
    v_mov_b32 v165, 0
    v_mov_b32 v166, 0
    v_mov_b32 v167, 0
    s_nop 1
    v_pk_mul_f32 v[14:15], v[168:169], v[120:121]
    v_pk_mul_f32 v[16:17], v[172:173], v[120:121]
    v_pk_mul_f32 v[18:19], v[170:171], v[122:123]
    v_pk_mul_f32 v[20:21], v[174:175], v[122:123]
    v_pk_fma_f32 v[14:15], v[172:173], v[128:129], v[14:15] neg_lo:[0,1,0] neg_hi:[0,1,0]
    v_pk_fma_f32 v[16:17], v[168:169], v[128:129], v[16:17]
    v_pk_fma_f32 v[18:19], v[174:175], v[130:131], v[18:19] neg_lo:[0,1,0] neg_hi:[0,1,0]
    v_pk_fma_f32 v[20:21], v[170:171], v[130:131], v[20:21]
    v_cvt_pk_bf16_f32 v184, v14, v15
    v_cvt_pk_bf16_f32 v188, v16, v17
    v_cvt_pk_bf16_f32 v185, v18, v19
    v_cvt_pk_bf16_f32 v189, v20, v21
    v_pk_mul_f32 v[14:15], v[176:177], v[124:125]
    v_pk_mul_f32 v[16:17], v[180:181], v[124:125]
    v_pk_mul_f32 v[18:19], v[178:179], v[126:127]
    v_pk_mul_f32 v[20:21], v[182:183], v[126:127]
    v_pk_fma_f32 v[14:15], v[180:181], v[132:133], v[14:15] neg_lo:[0,1,0] neg_hi:[0,1,0]
    v_pk_fma_f32 v[16:17], v[176:177], v[132:133], v[16:17]
    v_pk_fma_f32 v[18:19], v[182:183], v[134:135], v[18:19] neg_lo:[0,1,0] neg_hi:[0,1,0]
    v_pk_fma_f32 v[20:21], v[178:179], v[134:135], v[20:21]
    v_cvt_pk_bf16_f32 v186, v14, v15
    v_cvt_pk_bf16_f32 v190, v16, v17
    v_cvt_pk_bf16_f32 v187, v18, v19
    v_cvt_pk_bf16_f32 v191, v20, v21
    s_nop 1
    v_mfma_f32_16x16x32_bf16 v[152:155], v[184:187], v[56:59], v[152:155]
    v_mfma_f32_16x16x32_bf16 v[156:159], v[188:191], v[56:59], v[156:159]
    v_mfma_f32_16x16x32_bf16 v[160:163], v[184:187], v[60:63], v[160:163]
    v_mfma_f32_16x16x32_bf16 v[164:167], v[188:191], v[60:63], v[164:167]
    v_mfma_f32_16x16x32_bf16 v[152:155], v[188:191], v[72:75], v[152:155]
    v_mfma_f32_16x16x32_bf16 v[156:159], v[184:187], v[64:67], v[156:159]
    v_mfma_f32_16x16x32_bf16 v[160:163], v[188:191], v[76:79], v[160:163]
    v_mfma_f32_16x16x32_bf16 v[164:167], v[184:187], v[68:71], v[164:167]
    v_mov_b32 v168, 0
    v_mov_b32 v169, 0
    v_mov_b32 v170, 0
    v_mov_b32 v171, 0
    v_mov_b32 v172, 0
    v_mov_b32 v173, 0
    v_mov_b32 v174, 0
    v_mov_b32 v175, 0
    v_mov_b32 v176, 0
    v_mov_b32 v177, 0
    v_mov_b32 v178, 0
    v_mov_b32 v179, 0
    v_mov_b32 v180, 0
    v_mov_b32 v181, 0
    v_mov_b32 v182, 0
    v_mov_b32 v183, 0
    s_nop 1
    v_pk_mul_f32 v[14:15], v[152:153], v[96:97]
    v_pk_mul_f32 v[16:17], v[156:157], v[96:97]
    v_pk_mul_f32 v[18:19], v[154:155], v[98:99]
    v_pk_mul_f32 v[20:21], v[158:159], v[98:99]
    v_pk_fma_f32 v[14:15], v[156:157], v[104:105], v[14:15] neg_lo:[0,1,0] neg_hi:[0,1,0]
    v_pk_fma_f32 v[16:17], v[152:153], v[104:105], v[16:17]
    v_pk_fma_f32 v[18:19], v[158:159], v[106:107], v[18:19] neg_lo:[0,1,0] neg_hi:[0,1,0]
    v_pk_fma_f32 v[20:21], v[154:155], v[106:107], v[20:21]
    v_cvt_pk_bf16_f32 v120, v14, v15
    v_cvt_pk_bf16_f32 v124, v16, v17
    v_cvt_pk_bf16_f32 v121, v18, v19
    v_cvt_pk_bf16_f32 v125, v20, v21
    v_pk_mul_f32 v[14:15], v[160:161], v[100:101]
    v_pk_mul_f32 v[16:17], v[164:165], v[100:101]
    v_pk_mul_f32 v[18:19], v[162:163], v[102:103]
    v_pk_mul_f32 v[20:21], v[166:167], v[102:103]
    v_pk_fma_f32 v[14:15], v[164:165], v[108:109], v[14:15] neg_lo:[0,1,0] neg_hi:[0,1,0]
    v_pk_fma_f32 v[16:17], v[160:161], v[108:109], v[16:17]
    v_pk_fma_f32 v[18:19], v[166:167], v[110:111], v[18:19] neg_lo:[0,1,0] neg_hi:[0,1,0]
    v_pk_fma_f32 v[20:21], v[162:163], v[110:111], v[20:21]
    v_cvt_pk_bf16_f32 v122, v14, v15
    v_cvt_pk_bf16_f32 v126, v16, v17
    v_cvt_pk_bf16_f32 v123, v18, v19
    v_cvt_pk_bf16_f32 v127, v20, v21
    ds_write_b64 v9, v[120:121]
    ds_write_b64 v9, v[124:125] offset:4096
    ds_write_b64 v10, v[122:123]
    ds_write_b64 v10, v[126:127] offset:4096
    s_waitcnt lgkmcnt(0)
    s_barrier
    ds_read_b128 v[120:123], v11 offset:0
    ds_read_b128 v[128:131], v11 offset:512
    ds_read_b128 v[136:139], v11 offset:4096
    ds_read_b128 v[144:147], v11 offset:4608
    ds_read_b128 v[124:127], v12 offset:0
    ds_read_b128 v[132:135], v12 offset:512
    ds_read_b128 v[140:143], v12 offset:4096
    ds_read_b128 v[148:151], v12 offset:4608
    s_waitcnt lgkmcnt(6)
    v_mfma_f32_16x16x32_bf16 v[168:171], v[120:123], v[32:35], v[168:171]
    v_mfma_f32_16x16x32_bf16 v[172:175], v[120:123], v[40:43], v[172:175]
    v_mfma_f32_16x16x32_bf16 v[176:179], v[128:131], v[32:35], v[176:179]
    v_mfma_f32_16x16x32_bf16 v[180:183], v[128:131], v[40:43], v[180:183]
    s_waitcnt lgkmcnt(4)
    v_mfma_f32_16x16x32_bf16 v[168:171], v[136:139], v[48:51], v[168:171]
    v_mfma_f32_16x16x32_bf16 v[172:175], v[136:139], v[32:35], v[172:175]
    v_mfma_f32_16x16x32_bf16 v[176:179], v[144:147], v[48:51], v[176:179]
    v_mfma_f32_16x16x32_bf16 v[180:183], v[144:147], v[32:35], v[180:183]
    s_waitcnt lgkmcnt(2)
    v_mfma_f32_16x16x32_bf16 v[168:171], v[124:127], v[36:39], v[168:171]
    v_mfma_f32_16x16x32_bf16 v[172:175], v[124:127], v[44:47], v[172:175]
    v_mfma_f32_16x16x32_bf16 v[176:179], v[132:135], v[36:39], v[176:179]
    v_mfma_f32_16x16x32_bf16 v[180:183], v[132:135], v[44:47], v[180:183]
    s_waitcnt lgkmcnt(0)
    v_mfma_f32_16x16x32_bf16 v[168:171], v[140:143], v[52:55], v[168:171]
    v_mfma_f32_16x16x32_bf16 v[172:175], v[140:143], v[36:39], v[172:175]
    v_mfma_f32_16x16x32_bf16 v[176:179], v[148:151], v[52:55], v[176:179]
    v_mfma_f32_16x16x32_bf16 v[180:183], v[148:151], v[36:39], v[180:183]
    s_nop 7
    v_cvt_pk_bf16_f32 v184, v168, v169
    v_cvt_pk_bf16_f32 v185, v170, v171
    v_cvt_pk_bf16_f32 v186, v176, v177
    v_cvt_pk_bf16_f32 v187, v178, v179
    s_add_u32 s26, s25, 0
    buffer_store_dwordx4 v[184:187], v13, s[8:11], s26 offen sc1
    v_cvt_pk_bf16_f32 v188, v172, v173
    v_cvt_pk_bf16_f32 v189, v174, v175
    v_cvt_pk_bf16_f32 v190, v180, v181
    v_cvt_pk_bf16_f32 v191, v182, v183
    s_add_u32 s26, s25, 4096
    buffer_store_dwordx4 v[188:191], v13, s[8:11], s26 offen sc1
    s_mul_i32 s40, s16, 320
    s_add_u32 s40, s40, s27
    s_lshl_b32 s40, s40, 7
    s_add_u32 s40, s40, 24510464
    s_waitcnt vmcnt(0)
    v_mov_b32 v5, s46
    s_mov_b64 exec, 1
    buffer_store_dword v5, off, s[12:15], s40 sc1
    s_mov_b64 exec, -1
    s_mov_b32 s78, s46
    s_barrier
    s_branch k1_kernel_k345e
k1_kernel_side:
    v_lshrrev_b32 v1, 6, v0
    s_nop 0
    v_readfirstlane_b32 s24, v1
    s_cmp_ge_u32 s24, 4
    s_cbranch_scc1 k1_kernel_pw
    s_cmp_ge_u32 s2, 80
    s_cbranch_scc1 k1_kernel_clr
    s_load_dwordx2 s[32:33], s[0:1], 8
    s_load_dwordx2 s[16:17], s[0:1], 16
    s_mul_i32 s21, s2, 205
    s_lshr_b32 s21, s21, 11
    s_mul_i32 s22, s21, 10
    s_sub_u32 s22, s2, s22
    s_lshr_b32 s23, s21, 1
    s_lshl_b32 s23, s23, 4
    s_and_b32 s25, s21, 1
    s_lshl_b32 s25, s25, 10
    s_add_u32 s23, s23, s25
    s_lshl_b32 s25, s24, 8
    s_add_u32 s23, s23, s25
    v_bfe_u32 v2, v0, 2, 4
    v_add_u32 v1, s23, v2
    v_mul_u32_u24 v1, 642, v1
    v_and_b32 v3, 3, v0
    v_lshl_add_u32 v1, v3, 4, v1
    s_lshl_b32 s25, s22, 6
    s_add_u32 s25, s25, 2
    v_lshlrev_b32 v3, 16, v3
    v_lshl_add_u32 v2, v2, 4, v3
    s_waitcnt lgkmcnt(0)
    s_mov_b32 s8, s32
    s_mov_b32 s9, s33
    s_mov_b32 s10, 1314816
    s_mov_b32 s11, 0x00020000
    s_mov_b32 s28, s16
    s_mov_b32 s29, s17
    s_mov_b32 s30, 1314816
    s_mov_b32 s31, 0x00020000
    s_mov_b32 s12, s6
    s_mov_b32 s13, s7
    s_mov_b32 s14, 24772608
    s_mov_b32 s15, 0x00020000
    buffer_load_dwordx4 v[4:7], v1, s[8:11], s25 offen
    buffer_load_dwordx4 v[20:23], v1, s[28:31], s25 offen
    s_add_u32 s25, s25, 41088
    buffer_load_dwordx4 v[8:11], v1, s[8:11], s25 offen
    buffer_load_dwordx4 v[24:27], v1, s[28:31], s25 offen
    s_add_u32 s25, s25, 41088
    buffer_load_dwordx4 v[12:15], v1, s[8:11], s25 offen
    buffer_load_dwordx4 v[28:31], v1, s[28:31], s25 offen
    s_add_u32 s25, s25, 41088
    buffer_load_dwordx4 v[16:19], v1, s[8:11], s25 offen
    buffer_load_dwordx4 v[32:35], v1, s[28:31], s25 offen
    s_mov_b32 s26, 0x05040100
    s_mov_b32 s27, 0x07060302
    s_lshl_b32 s23, s22, 18
    s_lshl_b32 s25, s21, 10
    s_add_u32 s23, s23, s25
    s_lshl_b32 s25, s24, 8
    s_add_u32 s23, s23, s25
    s_add_u32 s23, s23, 2621440
    s_waitcnt vmcnt(0)
    v_perm_b32 v36, v20, v4, s26
    v_perm_b32 v37, v24, v8, s26
    v_perm_b32 v38, v28, v12, s26
    v_perm_b32 v39, v32, v16, s26
    buffer_store_dwordx4 v[36:39], v2, s[12:15], s23 offen sc1
    s_add_u32 s23, s23, 8192
    v_perm_b32 v40, v20, v4, s27
    v_perm_b32 v41, v24, v8, s27
    v_perm_b32 v42, v28, v12, s27
    v_perm_b32 v43, v32, v16, s27
    buffer_store_dwordx4 v[40:43], v2, s[12:15], s23 offen sc1
    s_add_u32 s23, s23, 8192
    v_perm_b32 v44, v21, v5, s26
    v_perm_b32 v45, v25, v9, s26
    v_perm_b32 v46, v29, v13, s26
    v_perm_b32 v47, v33, v17, s26
    buffer_store_dwordx4 v[44:47], v2, s[12:15], s23 offen sc1
    s_add_u32 s23, s23, 8192
    v_perm_b32 v48, v21, v5, s27
    v_perm_b32 v49, v25, v9, s27
    v_perm_b32 v50, v29, v13, s27
    v_perm_b32 v51, v33, v17, s27
    buffer_store_dwordx4 v[48:51], v2, s[12:15], s23 offen sc1
    s_add_u32 s23, s23, 8192
    v_perm_b32 v52, v22, v6, s26
    v_perm_b32 v53, v26, v10, s26
    v_perm_b32 v54, v30, v14, s26
    v_perm_b32 v55, v34, v18, s26
    buffer_store_dwordx4 v[52:55], v2, s[12:15], s23 offen sc1
    s_add_u32 s23, s23, 8192
    v_perm_b32 v56, v22, v6, s27
    v_perm_b32 v57, v26, v10, s27
    v_perm_b32 v58, v30, v14, s27
    v_perm_b32 v59, v34, v18, s27
    buffer_store_dwordx4 v[56:59], v2, s[12:15], s23 offen sc1
    s_add_u32 s23, s23, 8192
    v_perm_b32 v60, v23, v7, s26
    v_perm_b32 v61, v27, v11, s26
    v_perm_b32 v62, v31, v15, s26
    v_perm_b32 v63, v35, v19, s26
    buffer_store_dwordx4 v[60:63], v2, s[12:15], s23 offen sc1
    s_add_u32 s23, s23, 8192
    v_perm_b32 v64, v23, v7, s27
    v_perm_b32 v65, v27, v11, s27
    v_perm_b32 v66, v31, v15, s27
    v_perm_b32 v67, v35, v19, s27
    buffer_store_dwordx4 v[64:67], v2, s[12:15], s23 offen sc1
    s_mov_b32 s36, s42
    s_mov_b32 s37, s43
    s_mov_b32 s38, 256
    s_mov_b32 s39, 0x00020000
    s_lshl_b32 s40, s22, 3
    s_add_u32 s40, s40, s21
    s_lshl_b32 s40, s40, 2
    s_add_u32 s40, s40, s24
    s_lshl_b32 s40, s40, 7
    s_add_u32 s40, s40, 24461312
    s_mov_b32 s47, 20000
k1_kernel_nlp11:
    buffer_load_dword v1, off, s[36:39], 0 sc1
    s_waitcnt vmcnt(0)
    v_readfirstlane_b32 s46, v1
    s_sub_u32 s47, s47, 1
    s_cmp_eq_u32 s47, 0
    s_cbranch_scc1 k1_kernel_ndn12
    s_cmp_eq_u32 s46, 0
    s_cbranch_scc1 k1_kernel_nlp11
k1_kernel_ndn12:
    v_mov_b32 v1, s46
    s_mov_b64 exec, 1
    buffer_store_dword v1, off, s[12:15], s40 sc1
    s_mov_b64 exec, -1
    s_branch k1_kernel_pw
k1_kernel_clr:
    s_load_dwordx2 s[6:7], s[0:1], 72
    s_sub_u32 s21, s2, 80
    s_lshl_b32 s21, s21, 2
    s_add_u32 s21, s21, s24
    s_lshl_b32 s21, s21, 12
    s_add_u32 s21, s21, 24117248
    v_and_b32 v1, 63, v0
    v_lshlrev_b32 v1, 4, v1
    v_mov_b32 v4, 0
    v_mov_b32 v5, 0
    v_mov_b32 v6, 0
    v_mov_b32 v7, 0
    s_waitcnt lgkmcnt(0)
    s_mov_b32 s12, s6
    s_mov_b32 s13, s7
    s_mov_b32 s14, 24772608
    s_mov_b32 s15, 0x00020000
    s_cmp_lg_u32 s21, 24117248
    s_cbranch_scc1 k1_kernel_nonn13
    s_mov_b32 s36, s42
    s_mov_b32 s37, s43
    s_mov_b32 s38, 256
    s_mov_b32 s39, 0x00020000
    s_mov_b32 s22, 24506368
    buffer_load_dword v8, off, s[12:15], s22 sc1
    s_waitcnt vmcnt(0)
    v_add_u32 v8, 1, v8
    v_or_b32 v8, 0x80000000, v8
    s_mov_b64 exec, 1
    buffer_store_dword v8, off, s[36:39], 0 sc1
    buffer_store_dword v8, off, s[12:15], s22 sc1
    s_mov_b64 exec, -1
k1_kernel_nonn13:
k1_kernel_pw:
    s_waitcnt lgkmcnt(0)
    s_mov_b32 s36, s42
    s_mov_b32 s37, s43
    s_mov_b32 s38, 256
    s_mov_b32 s39, 0x00020000
    s_mov_b32 s47, 20000
k1_kernel_nlp14:
    buffer_load_dword v1, off, s[36:39], 0 sc1
    s_waitcnt vmcnt(0)
    v_readfirstlane_b32 s46, v1
    s_sub_u32 s47, s47, 1
    s_cmp_eq_u32 s47, 0
    s_cbranch_scc1 k1_kernel_ndn15
    s_cmp_eq_u32 s46, 0
    s_cbranch_scc1 k1_kernel_nlp14
k1_kernel_ndn15:
    s_mov_b32 s78, s46
    s_barrier
    s_load_dwordx2 s[32:33], s[0:1], 32
    s_load_dwordx2 s[34:35], s[0:1], 40
    s_load_dwordx2 s[36:37], s[0:1], 48
    s_load_dwordx2 s[38:39], s[0:1], 72
    v_and_b32 v1, 63, v0
    v_lshrrev_b32 v2, 6, v0
    s_sub_u32 s16, s2, 0
    v_readfirstlane_b32 s17, v2
    s_cmp_ge_u32 s16, 90
    s_cbranch_scc1 k1_kernel_pd
    s_lshl_b32 s18, s16, 3
    s_add_u32 s18, s18, s17
    s_lshl_b32 s19, s17, 13
    v_bfe_u32 v3, v1, 2, 2
    v_and_b32 v4, 3, v1
    v_lshrrev_b32 v5, 4, v1
    v_lshlrev_b32 v10, 4, v1
    s_cmp_ge_u32 s16, 60
    s_cbranch_scc1 k1_kernel_w2
    s_mul_i32 s20, s18, 2731
    s_lshr_b32 s20, s20, 16
    s_mul_i32 s21, s20, 24
    s_sub_u32 s21, s18, s21
    v_lshrrev_b32 v6, 3, v1
    v_mul_u32_u24 v6, 3072, v6
    v_and_b32 v7, 7, v1
    v_lshl_add_u32 v6, v7, 4, v6
    s_mul_i32 s22, s20, 98304
    s_lshl_b32 s23, s21, 7
    s_add_u32 s22, s22, s23
    s_waitcnt lgkmcnt(0)
    s_mov_b32 s8, s32
    s_mov_b32 s9, s33
    s_mov_b32 s10, 1966080
    s_mov_b32 s11, 0x00020000
    s_mov_b32 s12, s34
    s_mov_b32 s13, s35
    s_mov_b32 s14, 1966080
    s_mov_b32 s15, 0x00020000
    s_mov_b32 s40, s38
    s_mov_b32 s41, s39
    s_mov_b32 s42, 24772608
    s_mov_b32 s43, 0x00020000
    s_add_u32 m0, s19, 0
    s_add_u32 s24, s22, 0
    buffer_load_dwordx4 v6, s[8:11], s24 offen lds
    s_add_u32 m0, s19, 1024
    s_add_u32 s24, s22, 24576
    buffer_load_dwordx4 v6, s[8:11], s24 offen lds
    s_add_u32 m0, s19, 2048
    s_add_u32 s24, s22, 0
    buffer_load_dwordx4 v6, s[12:15], s24 offen lds
    s_add_u32 m0, s19, 3072
    s_add_u32 s24, s22, 24576
    buffer_load_dwordx4 v6, s[12:15], s24 offen lds
    s_add_u32 m0, s19, 4096
    s_add_u32 s24, s22, 49152
    buffer_load_dwordx4 v6, s[8:11], s24 offen lds
    s_add_u32 m0, s19, 5120
    s_add_u32 s24, s22, 73728
    buffer_load_dwordx4 v6, s[8:11], s24 offen lds
    s_add_u32 m0, s19, 6144
    s_add_u32 s24, s22, 49152
    buffer_load_dwordx4 v6, s[12:15], s24 offen lds
    s_add_u32 m0, s19, 7168
    s_add_u32 s24, s22, 73728
    buffer_load_dwordx4 v6, s[12:15], s24 offen lds
    v_and_b32 v7, 1, v5
    v_lshlrev_b32 v7, 11, v7
    v_lshrrev_b32 v8, 1, v5
    v_lshl_add_u32 v7, v8, 10, v7
    v_lshl_add_u32 v7, v3, 7, v7
    v_and_b32 v8, 1, v4
    v_lshlrev_b32 v8, 1, v8
    v_lshrrev_b32 v9, 1, v4
    v_or_b32 v8, v8, v9
    v_lshl_add_u32 v7, v8, 3, v7
    v_add_u32 v7, s19, v7
    s_waitcnt vmcnt(0)
    ds_read_b64_tr_b16 v[12:13], v7 offset:0
    ds_read_b64_tr_b16 v[14:15], v7 offset:512
    ds_read_b64_tr_b16 v[16:17], v7 offset:32
    ds_read_b64_tr_b16 v[18:19], v7 offset:544
    ds_read_b64_tr_b16 v[20:21], v7 offset:64
    ds_read_b64_tr_b16 v[22:23], v7 offset:576
    ds_read_b64_tr_b16 v[24:25], v7 offset:96
    ds_read_b64_tr_b16 v[26:27], v7 offset:608
    s_lshl_b32 s24, s21, 2
    s_add_u32 s24, s24, 0
    s_mul_i32 s25, s24, 43
    s_lshr_b32 s25, s25, 8
    s_mul_i32 s26, s25, 6
    s_sub_u32 s24, s24, s26
    s_mul_i32 s25, s25, 40
    s_lshl_b32 s26, s20, 1
    s_add_u32 s25, s25, s26
    s_add_u32 s25, s25, 0
    s_mul_i32 s25, s25, 6
    s_add_u32 s25, s25, s24
    s_lshl_b32 s25, s25, 10
    s_add_u32 s25, s25, 17825792
    s_waitcnt lgkmcnt(6)
    buffer_store_dwordx4 v[12:15], v10, s[40:43], s25 offen sc1
    s_lshl_b32 s24, s21, 2
    s_add_u32 s24, s24, 1
    s_mul_i32 s25, s24, 43
    s_lshr_b32 s25, s25, 8
    s_mul_i32 s26, s25, 6
    s_sub_u32 s24, s24, s26
    s_mul_i32 s25, s25, 40
    s_lshl_b32 s26, s20, 1
    s_add_u32 s25, s25, s26
    s_add_u32 s25, s25, 0
    s_mul_i32 s25, s25, 6
    s_add_u32 s25, s25, s24
    s_lshl_b32 s25, s25, 10
    s_add_u32 s25, s25, 17825792
    s_waitcnt lgkmcnt(4)
    buffer_store_dwordx4 v[16:19], v10, s[40:43], s25 offen sc1
    s_lshl_b32 s24, s21, 2
    s_add_u32 s24, s24, 2
    s_mul_i32 s25, s24, 43
    s_lshr_b32 s25, s25, 8
    s_mul_i32 s26, s25, 6
    s_sub_u32 s24, s24, s26
    s_mul_i32 s25, s25, 40
    s_lshl_b32 s26, s20, 1
    s_add_u32 s25, s25, s26
    s_add_u32 s25, s25, 0
    s_mul_i32 s25, s25, 6
    s_add_u32 s25, s25, s24
    s_lshl_b32 s25, s25, 10
    s_add_u32 s25, s25, 17825792
    s_waitcnt lgkmcnt(2)
    buffer_store_dwordx4 v[20:23], v10, s[40:43], s25 offen sc1
    s_lshl_b32 s24, s21, 2
    s_add_u32 s24, s24, 3
    s_mul_i32 s25, s24, 43
    s_lshr_b32 s25, s25, 8
    s_mul_i32 s26, s25, 6
    s_sub_u32 s24, s24, s26
    s_mul_i32 s25, s25, 40
    s_lshl_b32 s26, s20, 1
    s_add_u32 s25, s25, s26
    s_add_u32 s25, s25, 0
    s_mul_i32 s25, s25, 6
    s_add_u32 s25, s25, s24
    s_lshl_b32 s25, s25, 10
    s_add_u32 s25, s25, 17825792
    s_waitcnt lgkmcnt(0)
    buffer_store_dwordx4 v[24:27], v10, s[40:43], s25 offen sc1
    ds_read_b64_tr_b16 v[28:29], v7 offset:4096
    ds_read_b64_tr_b16 v[30:31], v7 offset:4608
    ds_read_b64_tr_b16 v[32:33], v7 offset:4128
    ds_read_b64_tr_b16 v[34:35], v7 offset:4640
    ds_read_b64_tr_b16 v[36:37], v7 offset:4160
    ds_read_b64_tr_b16 v[38:39], v7 offset:4672
    ds_read_b64_tr_b16 v[40:41], v7 offset:4192
    ds_read_b64_tr_b16 v[42:43], v7 offset:4704
    s_lshl_b32 s24, s21, 2
    s_add_u32 s24, s24, 0
    s_mul_i32 s25, s24, 43
    s_lshr_b32 s25, s25, 8
    s_mul_i32 s26, s25, 6
    s_sub_u32 s24, s24, s26
    s_mul_i32 s25, s25, 40
    s_lshl_b32 s26, s20, 1
    s_add_u32 s25, s25, s26
    s_add_u32 s25, s25, 1
    s_mul_i32 s25, s25, 6
    s_add_u32 s25, s25, s24
    s_lshl_b32 s25, s25, 10
    s_add_u32 s25, s25, 17825792
    s_waitcnt lgkmcnt(6)
    buffer_store_dwordx4 v[28:31], v10, s[40:43], s25 offen sc1
    s_lshl_b32 s24, s21, 2
    s_add_u32 s24, s24, 1
    s_mul_i32 s25, s24, 43
    s_lshr_b32 s25, s25, 8
    s_mul_i32 s26, s25, 6
    s_sub_u32 s24, s24, s26
    s_mul_i32 s25, s25, 40
    s_lshl_b32 s26, s20, 1
    s_add_u32 s25, s25, s26
    s_add_u32 s25, s25, 1
    s_mul_i32 s25, s25, 6
    s_add_u32 s25, s25, s24
    s_lshl_b32 s25, s25, 10
    s_add_u32 s25, s25, 17825792
    s_waitcnt lgkmcnt(4)
    buffer_store_dwordx4 v[32:35], v10, s[40:43], s25 offen sc1
    s_lshl_b32 s24, s21, 2
    s_add_u32 s24, s24, 2
    s_mul_i32 s25, s24, 43
    s_lshr_b32 s25, s25, 8
    s_mul_i32 s26, s25, 6
    s_sub_u32 s24, s24, s26
    s_mul_i32 s25, s25, 40
    s_lshl_b32 s26, s20, 1
    s_add_u32 s25, s25, s26
    s_add_u32 s25, s25, 1
    s_mul_i32 s25, s25, 6
    s_add_u32 s25, s25, s24
    s_lshl_b32 s25, s25, 10
    s_add_u32 s25, s25, 17825792
    s_waitcnt lgkmcnt(2)
    buffer_store_dwordx4 v[36:39], v10, s[40:43], s25 offen sc1
    s_lshl_b32 s24, s21, 2
    s_add_u32 s24, s24, 3
    s_mul_i32 s25, s24, 43
    s_lshr_b32 s25, s25, 8
    s_mul_i32 s26, s25, 6
    s_sub_u32 s24, s24, s26
    s_mul_i32 s25, s25, 40
    s_lshl_b32 s26, s20, 1
    s_add_u32 s25, s25, s26
    s_add_u32 s25, s25, 1
    s_mul_i32 s25, s25, 6
    s_add_u32 s25, s25, s24
    s_lshl_b32 s25, s25, 10
    s_add_u32 s25, s25, 17825792
    s_waitcnt lgkmcnt(0)
    buffer_store_dwordx4 v[40:43], v10, s[40:43], s25 offen sc1
    s_branch k1_kernel_pd
k1_kernel_w2:
    s_sub_u32 s18, s18, 480
    s_mul_i32 s20, s18, 205
    s_lshr_b32 s20, s20, 11
    s_mul_i32 s21, s20, 10
    s_sub_u32 s21, s18, s21
    v_lshrrev_b32 v6, 3, v1
    v_mul_u32_u24 v6, 1280, v6
    v_and_b32 v7, 7, v1
    v_lshl_add_u32 v6, v7, 4, v6
    s_mul_i32 s22, s20, 81920
    s_lshl_b32 s23, s21, 7
    s_add_u32 s22, s22, s23
    s_waitcnt lgkmcnt(0)
    s_mov_b32 s8, s36
    s_mov_b32 s9, s37
    s_mov_b32 s10, 1966080
    s_mov_b32 s11, 0x00020000
    s_mov_b32 s40, s38
    s_mov_b32 s41, s39
    s_mov_b32 s42, 24772608
    s_mov_b32 s43, 0x00020000
    s_add_u32 m0, s19, 0
    s_add_u32 s24, s22, 0
    buffer_load_dwordx4 v6, s[8:11], s24 offen lds
    s_add_u32 m0, s19, 1024
    s_add_u32 s24, s22, 10240
    buffer_load_dwordx4 v6, s[8:11], s24 offen lds
    s_add_u32 m0, s19, 2048
    s_add_u32 s24, s22, 20480
    buffer_load_dwordx4 v6, s[8:11], s24 offen lds
    s_add_u32 m0, s19, 3072
    s_add_u32 s24, s22, 30720
    buffer_load_dwordx4 v6, s[8:11], s24 offen lds
    s_add_u32 m0, s19, 4096
    s_add_u32 s24, s22, 40960
    buffer_load_dwordx4 v6, s[8:11], s24 offen lds
    s_add_u32 m0, s19, 5120
    s_add_u32 s24, s22, 51200
    buffer_load_dwordx4 v6, s[8:11], s24 offen lds
    s_add_u32 m0, s19, 6144
    s_add_u32 s24, s22, 61440
    buffer_load_dwordx4 v6, s[8:11], s24 offen lds
    s_add_u32 m0, s19, 7168
    s_add_u32 s24, s22, 71680
    buffer_load_dwordx4 v6, s[8:11], s24 offen lds
    v_lshlrev_b32 v7, 10, v5
    v_lshl_add_u32 v7, v3, 7, v7
    v_lshl_add_u32 v7, v4, 3, v7
    v_add_u32 v7, s19, v7
    s_waitcnt vmcnt(0)
    s_mul_i32 s24, s20, 80
    s_lshl_b32 s25, s21, 2
    s_add_u32 s24, s24, s25
    s_lshl_b32 s24, s24, 10
    s_add_u32 s24, s24, 22020096
    ds_read_b64_tr_b16 v[12:13], v7 offset:0
    ds_read_b64_tr_b16 v[14:15], v7 offset:512
    ds_read_b64_tr_b16 v[16:17], v7 offset:32
    ds_read_b64_tr_b16 v[18:19], v7 offset:544
    ds_read_b64_tr_b16 v[20:21], v7 offset:64
    ds_read_b64_tr_b16 v[22:23], v7 offset:576
    ds_read_b64_tr_b16 v[24:25], v7 offset:96
    ds_read_b64_tr_b16 v[26:27], v7 offset:608
    s_add_u32 s25, s24, 0
    s_waitcnt lgkmcnt(6)
    buffer_store_dwordx4 v[12:15], v10, s[40:43], s25 offen sc1
    s_add_u32 s25, s24, 1024
    s_waitcnt lgkmcnt(4)
    buffer_store_dwordx4 v[16:19], v10, s[40:43], s25 offen sc1
    s_add_u32 s25, s24, 2048
    s_waitcnt lgkmcnt(2)
    buffer_store_dwordx4 v[20:23], v10, s[40:43], s25 offen sc1
    s_add_u32 s25, s24, 3072
    s_waitcnt lgkmcnt(0)
    buffer_store_dwordx4 v[24:27], v10, s[40:43], s25 offen sc1
    ds_read_b64_tr_b16 v[28:29], v7 offset:4096
    ds_read_b64_tr_b16 v[30:31], v7 offset:4608
    ds_read_b64_tr_b16 v[32:33], v7 offset:4128
    ds_read_b64_tr_b16 v[34:35], v7 offset:4640
    ds_read_b64_tr_b16 v[36:37], v7 offset:4160
    ds_read_b64_tr_b16 v[38:39], v7 offset:4672
    ds_read_b64_tr_b16 v[40:41], v7 offset:4192
    ds_read_b64_tr_b16 v[42:43], v7 offset:4704
    s_add_u32 s25, s24, 40960
    s_waitcnt lgkmcnt(6)
    buffer_store_dwordx4 v[28:31], v10, s[40:43], s25 offen sc1
    s_add_u32 s25, s24, 41984
    s_waitcnt lgkmcnt(4)
    buffer_store_dwordx4 v[32:35], v10, s[40:43], s25 offen sc1
    s_add_u32 s25, s24, 43008
    s_waitcnt lgkmcnt(2)
    buffer_store_dwordx4 v[36:39], v10, s[40:43], s25 offen sc1
    s_add_u32 s25, s24, 44032
    s_waitcnt lgkmcnt(0)
    buffer_store_dwordx4 v[40:43], v10, s[40:43], s25 offen sc1
    s_branch k1_kernel_pd
k1_kernel_pd:
    s_waitcnt vmcnt(0) lgkmcnt(0)
    s_barrier
    v_lshrrev_b32 v1, 6, v0
    s_nop 0
    v_readfirstlane_b32 s24, v1
    s_cmp_ge_u32 s2, 90
    s_cbranch_scc1 k1_kernel_k345e
    s_cmp_lg_u32 s24, 0
    s_cbranch_scc1 k1_kernel_k345e
    s_load_dwordx2 s[6:7], s[0:1], 72
    s_lshl_b32 s40, s2, 7
    s_add_u32 s40, s40, 24707072
    s_waitcnt lgkmcnt(0)
    s_mov_b32 s12, s6
    s_mov_b32 s13, s7
    s_mov_b32 s14, 24772608
    s_mov_b32 s15, 0x00020000
    v_mov_b32 v1, s46
    s_mov_b64 exec, 1
    buffer_store_dword v1, off, s[12:15], s40 sc1
    s_mov_b64 exec, -1
k1_kernel_k345e:
    s_sub_u32 s2, s2, 96
    s_and_b32 s2, s2, 255
    s_cmp_ge_u32 s2, 256
    s_cbranch_scc1 k345_end
    s_load_dwordx2 s[6:7], s[0:1], 72
    s_load_dwordx2 s[58:59], s[0:1], 56
    s_load_dwordx2 s[4:5], s[0:1], 0
    s_getpc_b64 s[60:61]
k1_kernel_pf16:
    v_lshlrev_b32 v254, 7, v0
    v_min_u32 v254, k1_kernel_codeend-k1_kernel_pf16-4, v254
    global_load_dword v255, v254, s[60:61]
    s_cmp_ge_u32 s2, 160
    s_cbranch_scc1 k345_p4
    v_and_b32 v1, 63, v0
    v_lshrrev_b32 v2, 6, v0
    s_sub_u32 s27, s2, 0
    s_and_b32 s22, s27, 7
    s_lshr_b32 s23, s27, 3
    s_mul_i32 s24, s23, 52
    s_lshr_b32 s24, s24, 8
    s_mul_i32 s25, s24, 5
    s_sub_u32 s18, s23, s25
    s_lshl_b32 s24, s24, 3
    s_add_u32 s17, s24, s22
    v_readfirstlane_b32 s21, v2
    s_and_b32 s16, s21, 3
    s_cmp_ge_u32 s21, 4
    s_cbranch_scc1 k345_p3_prod
    v_and_b32 v2, 19, v1
    v_bfe_u32 v3, v1, 2, 1
    v_lshl_or_b32 v2, v3, 3, v2
    v_bfe_u32 v3, v1, 3, 1
    v_lshl_or_b32 v2, v3, 2, v2
    s_lshl_b32 s26, s18, 2
    s_add_u32 s26, s26, s16
    s_lshl_b32 s24, s26, 5
    v_add_u32 v2, s24, v2
    v_cvt_f32_u32 v18, v2
    v_lshrrev_b32 v3, 5, v1
    v_cvt_f32_u32 v19, v3
    v_mul_f32 v14, 0x3acccccd, v18
    v_mul_f32 v19, 0x3e800000, v19
    v_add_f32 v13, v19, v14
    v_mul_f32 v15, 0x3d800000, v18
    v_fract_f32 v15, v15
    v_add_f32 v18, v14, v14
    v_cos_f32 v16, v18
    s_nop 0
    v_add_f32 v16, v16, v16
    v_add_f32 v24, v13, v14
    v_cos_f32 v18, v13
    v_cos_f32 v19, v24
    v_add_f32 v25, v24, v14
    v_add_f32 v24, v25, v14
    v_cos_f32 v20, v25
    v_cos_f32 v21, v24
    v_cvt_pk_bf16_f32 v84, v18, v19
    s_nop 0
    v_cvt_pk_bf16_f32 v85, v20, v21
    v_pk_fma_f32 v[22:23], v[16:17], v[20:21], v[18:19] op_sel_hi:[0,1,1] neg_lo:[0,0,1] neg_hi:[0,0,1]
    v_cvt_pk_bf16_f32 v86, v22, v23
    v_pk_fma_f32 v[18:19], v[16:17], v[22:23], v[20:21] op_sel_hi:[0,1,1] neg_lo:[0,0,1] neg_hi:[0,0,1]
    v_cvt_pk_bf16_f32 v87, v18, v19
    v_pk_fma_f32 v[20:21], v[16:17], v[18:19], v[22:23] op_sel_hi:[0,1,1] neg_lo:[0,0,1] neg_hi:[0,0,1]
    v_cvt_pk_bf16_f32 v88, v20, v21
    v_pk_fma_f32 v[22:23], v[16:17], v[20:21], v[18:19] op_sel_hi:[0,1,1] neg_lo:[0,0,1] neg_hi:[0,0,1]
    v_cvt_pk_bf16_f32 v89, v22, v23
    v_pk_fma_f32 v[18:19], v[16:17], v[22:23], v[20:21] op_sel_hi:[0,1,1] neg_lo:[0,0,1] neg_hi:[0,0,1]
    v_cvt_pk_bf16_f32 v90, v18, v19
    v_pk_fma_f32 v[20:21], v[16:17], v[18:19], v[22:23] op_sel_hi:[0,1,1] neg_lo:[0,0,1] neg_hi:[0,0,1]
    v_cvt_pk_bf16_f32 v91, v20, v21
    v_pk_fma_f32 v[22:23], v[16:17], v[20:21], v[18:19] op_sel_hi:[0,1,1] neg_lo:[0,0,1] neg_hi:[0,0,1]
    v_cvt_pk_bf16_f32 v92, v22, v23
    v_pk_fma_f32 v[18:19], v[16:17], v[22:23], v[20:21] op_sel_hi:[0,1,1] neg_lo:[0,0,1] neg_hi:[0,0,1]
    v_cvt_pk_bf16_f32 v93, v18, v19
    v_pk_fma_f32 v[20:21], v[16:17], v[18:19], v[22:23] op_sel_hi:[0,1,1] neg_lo:[0,0,1] neg_hi:[0,0,1]
    v_cvt_pk_bf16_f32 v94, v20, v21
    v_pk_fma_f32 v[22:23], v[16:17], v[20:21], v[18:19] op_sel_hi:[0,1,1] neg_lo:[0,0,1] neg_hi:[0,0,1]
    v_cvt_pk_bf16_f32 v95, v22, v23
    v_pk_fma_f32 v[18:19], v[16:17], v[22:23], v[20:21] op_sel_hi:[0,1,1] neg_lo:[0,0,1] neg_hi:[0,0,1]
    v_cvt_pk_bf16_f32 v96, v18, v19
    v_pk_fma_f32 v[20:21], v[16:17], v[18:19], v[22:23] op_sel_hi:[0,1,1] neg_lo:[0,0,1] neg_hi:[0,0,1]
    v_cvt_pk_bf16_f32 v97, v20, v21
    v_pk_fma_f32 v[22:23], v[16:17], v[20:21], v[18:19] op_sel_hi:[0,1,1] neg_lo:[0,0,1] neg_hi:[0,0,1]
    v_cvt_pk_bf16_f32 v98, v22, v23
    v_pk_fma_f32 v[18:19], v[16:17], v[22:23], v[20:21] op_sel_hi:[0,1,1] neg_lo:[0,0,1] neg_hi:[0,0,1]
    v_cvt_pk_bf16_f32 v99, v18, v19
    v_pk_fma_f32 v[20:21], v[16:17], v[18:19], v[22:23] op_sel_hi:[0,1,1] neg_lo:[0,0,1] neg_hi:[0,0,1]
    v_cvt_pk_bf16_f32 v100, v20, v21
    v_pk_fma_f32 v[22:23], v[16:17], v[20:21], v[18:19] op_sel_hi:[0,1,1] neg_lo:[0,0,1] neg_hi:[0,0,1]
    v_cvt_pk_bf16_f32 v101, v22, v23
    v_pk_fma_f32 v[18:19], v[16:17], v[22:23], v[20:21] op_sel_hi:[0,1,1] neg_lo:[0,0,1] neg_hi:[0,0,1]
    v_cvt_pk_bf16_f32 v102, v18, v19
    v_pk_fma_f32 v[20:21], v[16:17], v[18:19], v[22:23] op_sel_hi:[0,1,1] neg_lo:[0,0,1] neg_hi:[0,0,1]
    v_cvt_pk_bf16_f32 v103, v20, v21
    v_add_f32 v13, v13, v15
    v_fract_f32 v13, v13
    v_add_f32 v24, v13, v14
    v_cos_f32 v18, v13
    v_cos_f32 v19, v24
    v_add_f32 v25, v24, v14
    v_add_f32 v24, v25, v14
    v_cos_f32 v20, v25
    v_cos_f32 v21, v24
    v_cvt_pk_bf16_f32 v104, v18, v19
    s_nop 0
    v_cvt_pk_bf16_f32 v105, v20, v21
    v_pk_fma_f32 v[22:23], v[16:17], v[20:21], v[18:19] op_sel_hi:[0,1,1] neg_lo:[0,0,1] neg_hi:[0,0,1]
    v_cvt_pk_bf16_f32 v106, v22, v23
    v_pk_fma_f32 v[18:19], v[16:17], v[22:23], v[20:21] op_sel_hi:[0,1,1] neg_lo:[0,0,1] neg_hi:[0,0,1]
    v_cvt_pk_bf16_f32 v107, v18, v19
    v_pk_fma_f32 v[20:21], v[16:17], v[18:19], v[22:23] op_sel_hi:[0,1,1] neg_lo:[0,0,1] neg_hi:[0,0,1]
    v_cvt_pk_bf16_f32 v108, v20, v21
    v_pk_fma_f32 v[22:23], v[16:17], v[20:21], v[18:19] op_sel_hi:[0,1,1] neg_lo:[0,0,1] neg_hi:[0,0,1]
    v_cvt_pk_bf16_f32 v109, v22, v23
    v_pk_fma_f32 v[18:19], v[16:17], v[22:23], v[20:21] op_sel_hi:[0,1,1] neg_lo:[0,0,1] neg_hi:[0,0,1]
    v_cvt_pk_bf16_f32 v110, v18, v19
    v_pk_fma_f32 v[20:21], v[16:17], v[18:19], v[22:23] op_sel_hi:[0,1,1] neg_lo:[0,0,1] neg_hi:[0,0,1]
    v_cvt_pk_bf16_f32 v111, v20, v21
    v_pk_fma_f32 v[22:23], v[16:17], v[20:21], v[18:19] op_sel_hi:[0,1,1] neg_lo:[0,0,1] neg_hi:[0,0,1]
    v_cvt_pk_bf16_f32 v112, v22, v23
    v_pk_fma_f32 v[18:19], v[16:17], v[22:23], v[20:21] op_sel_hi:[0,1,1] neg_lo:[0,0,1] neg_hi:[0,0,1]
    v_cvt_pk_bf16_f32 v113, v18, v19
    v_pk_fma_f32 v[20:21], v[16:17], v[18:19], v[22:23] op_sel_hi:[0,1,1] neg_lo:[0,0,1] neg_hi:[0,0,1]
    v_cvt_pk_bf16_f32 v114, v20, v21
    v_pk_fma_f32 v[22:23], v[16:17], v[20:21], v[18:19] op_sel_hi:[0,1,1] neg_lo:[0,0,1] neg_hi:[0,0,1]
    v_cvt_pk_bf16_f32 v115, v22, v23
    v_pk_fma_f32 v[18:19], v[16:17], v[22:23], v[20:21] op_sel_hi:[0,1,1] neg_lo:[0,0,1] neg_hi:[0,0,1]
    v_cvt_pk_bf16_f32 v116, v18, v19
    v_pk_fma_f32 v[20:21], v[16:17], v[18:19], v[22:23] op_sel_hi:[0,1,1] neg_lo:[0,0,1] neg_hi:[0,0,1]
    v_cvt_pk_bf16_f32 v117, v20, v21
    v_pk_fma_f32 v[22:23], v[16:17], v[20:21], v[18:19] op_sel_hi:[0,1,1] neg_lo:[0,0,1] neg_hi:[0,0,1]
    v_cvt_pk_bf16_f32 v118, v22, v23
    v_pk_fma_f32 v[18:19], v[16:17], v[22:23], v[20:21] op_sel_hi:[0,1,1] neg_lo:[0,0,1] neg_hi:[0,0,1]
    v_cvt_pk_bf16_f32 v119, v18, v19
    v_pk_fma_f32 v[20:21], v[16:17], v[18:19], v[22:23] op_sel_hi:[0,1,1] neg_lo:[0,0,1] neg_hi:[0,0,1]
    v_cvt_pk_bf16_f32 v120, v20, v21
    v_pk_fma_f32 v[22:23], v[16:17], v[20:21], v[18:19] op_sel_hi:[0,1,1] neg_lo:[0,0,1] neg_hi:[0,0,1]
    v_cvt_pk_bf16_f32 v121, v22, v23
    v_pk_fma_f32 v[18:19], v[16:17], v[22:23], v[20:21] op_sel_hi:[0,1,1] neg_lo:[0,0,1] neg_hi:[0,0,1]
    v_cvt_pk_bf16_f32 v122, v18, v19
    v_pk_fma_f32 v[20:21], v[16:17], v[18:19], v[22:23] op_sel_hi:[0,1,1] neg_lo:[0,0,1] neg_hi:[0,0,1]
    v_cvt_pk_bf16_f32 v123, v20, v21
    v_add_f32 v13, v13, v15
    v_fract_f32 v13, v13
    v_add_f32 v24, v13, v14
    v_cos_f32 v18, v13
    v_cos_f32 v19, v24
    v_add_f32 v25, v24, v14
    v_add_f32 v24, v25, v14
    v_cos_f32 v20, v25
    v_cos_f32 v21, v24
    v_cvt_pk_bf16_f32 v124, v18, v19
    s_nop 0
    v_cvt_pk_bf16_f32 v125, v20, v21
    v_pk_fma_f32 v[22:23], v[16:17], v[20:21], v[18:19] op_sel_hi:[0,1,1] neg_lo:[0,0,1] neg_hi:[0,0,1]
    v_cvt_pk_bf16_f32 v126, v22, v23
    v_pk_fma_f32 v[18:19], v[16:17], v[22:23], v[20:21] op_sel_hi:[0,1,1] neg_lo:[0,0,1] neg_hi:[0,0,1]
    v_cvt_pk_bf16_f32 v127, v18, v19
    v_pk_fma_f32 v[20:21], v[16:17], v[18:19], v[22:23] op_sel_hi:[0,1,1] neg_lo:[0,0,1] neg_hi:[0,0,1]
    v_cvt_pk_bf16_f32 v128, v20, v21
    v_pk_fma_f32 v[22:23], v[16:17], v[20:21], v[18:19] op_sel_hi:[0,1,1] neg_lo:[0,0,1] neg_hi:[0,0,1]
    v_cvt_pk_bf16_f32 v129, v22, v23
    v_pk_fma_f32 v[18:19], v[16:17], v[22:23], v[20:21] op_sel_hi:[0,1,1] neg_lo:[0,0,1] neg_hi:[0,0,1]
    v_cvt_pk_bf16_f32 v130, v18, v19
    v_pk_fma_f32 v[20:21], v[16:17], v[18:19], v[22:23] op_sel_hi:[0,1,1] neg_lo:[0,0,1] neg_hi:[0,0,1]
    v_cvt_pk_bf16_f32 v131, v20, v21
    v_pk_fma_f32 v[22:23], v[16:17], v[20:21], v[18:19] op_sel_hi:[0,1,1] neg_lo:[0,0,1] neg_hi:[0,0,1]
    v_cvt_pk_bf16_f32 v132, v22, v23
    v_pk_fma_f32 v[18:19], v[16:17], v[22:23], v[20:21] op_sel_hi:[0,1,1] neg_lo:[0,0,1] neg_hi:[0,0,1]
    v_cvt_pk_bf16_f32 v133, v18, v19
    v_pk_fma_f32 v[20:21], v[16:17], v[18:19], v[22:23] op_sel_hi:[0,1,1] neg_lo:[0,0,1] neg_hi:[0,0,1]
    v_cvt_pk_bf16_f32 v134, v20, v21
    v_pk_fma_f32 v[22:23], v[16:17], v[20:21], v[18:19] op_sel_hi:[0,1,1] neg_lo:[0,0,1] neg_hi:[0,0,1]
    v_cvt_pk_bf16_f32 v135, v22, v23
    v_pk_fma_f32 v[18:19], v[16:17], v[22:23], v[20:21] op_sel_hi:[0,1,1] neg_lo:[0,0,1] neg_hi:[0,0,1]
    v_cvt_pk_bf16_f32 v136, v18, v19
    v_pk_fma_f32 v[20:21], v[16:17], v[18:19], v[22:23] op_sel_hi:[0,1,1] neg_lo:[0,0,1] neg_hi:[0,0,1]
    v_cvt_pk_bf16_f32 v137, v20, v21
    v_pk_fma_f32 v[22:23], v[16:17], v[20:21], v[18:19] op_sel_hi:[0,1,1] neg_lo:[0,0,1] neg_hi:[0,0,1]
    v_cvt_pk_bf16_f32 v138, v22, v23
    v_pk_fma_f32 v[18:19], v[16:17], v[22:23], v[20:21] op_sel_hi:[0,1,1] neg_lo:[0,0,1] neg_hi:[0,0,1]
    v_cvt_pk_bf16_f32 v139, v18, v19
    v_pk_fma_f32 v[20:21], v[16:17], v[18:19], v[22:23] op_sel_hi:[0,1,1] neg_lo:[0,0,1] neg_hi:[0,0,1]
    v_cvt_pk_bf16_f32 v140, v20, v21
    v_pk_fma_f32 v[22:23], v[16:17], v[20:21], v[18:19] op_sel_hi:[0,1,1] neg_lo:[0,0,1] neg_hi:[0,0,1]
    v_cvt_pk_bf16_f32 v141, v22, v23
    v_pk_fma_f32 v[18:19], v[16:17], v[22:23], v[20:21] op_sel_hi:[0,1,1] neg_lo:[0,0,1] neg_hi:[0,0,1]
    v_cvt_pk_bf16_f32 v142, v18, v19
    v_pk_fma_f32 v[20:21], v[16:17], v[18:19], v[22:23] op_sel_hi:[0,1,1] neg_lo:[0,0,1] neg_hi:[0,0,1]
    v_cvt_pk_bf16_f32 v143, v20, v21
    v_add_f32 v13, v13, v15
    v_fract_f32 v13, v13
    s_waitcnt lgkmcnt(0)
    s_mov_b32 s12, s6
    s_mov_b32 s13, s7
    s_mov_b32 s14, 24772608
    s_mov_b32 s15, 0x00020000
    v_add_f32 v24, v13, v14
    v_cos_f32 v18, v13
    v_cos_f32 v19, v24
    v_add_f32 v25, v24, v14
    v_add_f32 v24, v25, v14
    v_cos_f32 v20, v25
    v_cos_f32 v21, v24
    v_cvt_pk_bf16_f32 v144, v18, v19
    s_nop 0
    v_cvt_pk_bf16_f32 v145, v20, v21
    v_pk_fma_f32 v[22:23], v[16:17], v[20:21], v[18:19] op_sel_hi:[0,1,1] neg_lo:[0,0,1] neg_hi:[0,0,1]
    v_cvt_pk_bf16_f32 v146, v22, v23
    v_pk_fma_f32 v[18:19], v[16:17], v[22:23], v[20:21] op_sel_hi:[0,1,1] neg_lo:[0,0,1] neg_hi:[0,0,1]
    v_cvt_pk_bf16_f32 v147, v18, v19
    v_pk_fma_f32 v[20:21], v[16:17], v[18:19], v[22:23] op_sel_hi:[0,1,1] neg_lo:[0,0,1] neg_hi:[0,0,1]
    v_cvt_pk_bf16_f32 v148, v20, v21
    v_pk_fma_f32 v[22:23], v[16:17], v[20:21], v[18:19] op_sel_hi:[0,1,1] neg_lo:[0,0,1] neg_hi:[0,0,1]
    v_cvt_pk_bf16_f32 v149, v22, v23
    v_pk_fma_f32 v[18:19], v[16:17], v[22:23], v[20:21] op_sel_hi:[0,1,1] neg_lo:[0,0,1] neg_hi:[0,0,1]
    v_cvt_pk_bf16_f32 v150, v18, v19
    v_pk_fma_f32 v[20:21], v[16:17], v[18:19], v[22:23] op_sel_hi:[0,1,1] neg_lo:[0,0,1] neg_hi:[0,0,1]
    v_cvt_pk_bf16_f32 v151, v20, v21
    v_pk_fma_f32 v[22:23], v[16:17], v[20:21], v[18:19] op_sel_hi:[0,1,1] neg_lo:[0,0,1] neg_hi:[0,0,1]
    v_cvt_pk_bf16_f32 v152, v22, v23
    v_pk_fma_f32 v[18:19], v[16:17], v[22:23], v[20:21] op_sel_hi:[0,1,1] neg_lo:[0,0,1] neg_hi:[0,0,1]
    v_cvt_pk_bf16_f32 v153, v18, v19
    v_pk_fma_f32 v[20:21], v[16:17], v[18:19], v[22:23] op_sel_hi:[0,1,1] neg_lo:[0,0,1] neg_hi:[0,0,1]
    v_cvt_pk_bf16_f32 v154, v20, v21
    v_pk_fma_f32 v[22:23], v[16:17], v[20:21], v[18:19] op_sel_hi:[0,1,1] neg_lo:[0,0,1] neg_hi:[0,0,1]
    v_cvt_pk_bf16_f32 v155, v22, v23
    v_pk_fma_f32 v[18:19], v[16:17], v[22:23], v[20:21] op_sel_hi:[0,1,1] neg_lo:[0,0,1] neg_hi:[0,0,1]
    v_cvt_pk_bf16_f32 v156, v18, v19
    v_pk_fma_f32 v[20:21], v[16:17], v[18:19], v[22:23] op_sel_hi:[0,1,1] neg_lo:[0,0,1] neg_hi:[0,0,1]
    v_cvt_pk_bf16_f32 v157, v20, v21
    v_pk_fma_f32 v[22:23], v[16:17], v[20:21], v[18:19] op_sel_hi:[0,1,1] neg_lo:[0,0,1] neg_hi:[0,0,1]
    v_cvt_pk_bf16_f32 v158, v22, v23
    v_pk_fma_f32 v[18:19], v[16:17], v[22:23], v[20:21] op_sel_hi:[0,1,1] neg_lo:[0,0,1] neg_hi:[0,0,1]
    v_cvt_pk_bf16_f32 v159, v18, v19
    v_pk_fma_f32 v[20:21], v[16:17], v[18:19], v[22:23] op_sel_hi:[0,1,1] neg_lo:[0,0,1] neg_hi:[0,0,1]
    v_cvt_pk_bf16_f32 v160, v20, v21
    v_pk_fma_f32 v[22:23], v[16:17], v[20:21], v[18:19] op_sel_hi:[0,1,1] neg_lo:[0,0,1] neg_hi:[0,0,1]
    v_cvt_pk_bf16_f32 v161, v22, v23
    v_pk_fma_f32 v[18:19], v[16:17], v[22:23], v[20:21] op_sel_hi:[0,1,1] neg_lo:[0,0,1] neg_hi:[0,0,1]
    v_cvt_pk_bf16_f32 v162, v18, v19
    v_pk_fma_f32 v[20:21], v[16:17], v[18:19], v[22:23] op_sel_hi:[0,1,1] neg_lo:[0,0,1] neg_hi:[0,0,1]
    v_cvt_pk_bf16_f32 v163, v20, v21
    v_add_f32 v13, v13, v15
    v_fract_f32 v13, v13
    v_add_f32 v24, v13, v14
    v_cos_f32 v18, v13
    v_cos_f32 v19, v24
    v_add_f32 v25, v24, v14
    v_add_f32 v24, v25, v14
    v_cos_f32 v20, v25
    v_cos_f32 v21, v24
    v_cvt_pk_bf16_f32 v164, v18, v19
    s_nop 0
    v_cvt_pk_bf16_f32 v165, v20, v21
    v_pk_fma_f32 v[22:23], v[16:17], v[20:21], v[18:19] op_sel_hi:[0,1,1] neg_lo:[0,0,1] neg_hi:[0,0,1]
    v_cvt_pk_bf16_f32 v166, v22, v23
    v_pk_fma_f32 v[18:19], v[16:17], v[22:23], v[20:21] op_sel_hi:[0,1,1] neg_lo:[0,0,1] neg_hi:[0,0,1]
    v_cvt_pk_bf16_f32 v167, v18, v19
    v_pk_fma_f32 v[20:21], v[16:17], v[18:19], v[22:23] op_sel_hi:[0,1,1] neg_lo:[0,0,1] neg_hi:[0,0,1]
    v_cvt_pk_bf16_f32 v168, v20, v21
    v_pk_fma_f32 v[22:23], v[16:17], v[20:21], v[18:19] op_sel_hi:[0,1,1] neg_lo:[0,0,1] neg_hi:[0,0,1]
    v_cvt_pk_bf16_f32 v169, v22, v23
    v_pk_fma_f32 v[18:19], v[16:17], v[22:23], v[20:21] op_sel_hi:[0,1,1] neg_lo:[0,0,1] neg_hi:[0,0,1]
    v_cvt_pk_bf16_f32 v170, v18, v19
    v_pk_fma_f32 v[20:21], v[16:17], v[18:19], v[22:23] op_sel_hi:[0,1,1] neg_lo:[0,0,1] neg_hi:[0,0,1]
    v_cvt_pk_bf16_f32 v171, v20, v21
    v_pk_fma_f32 v[22:23], v[16:17], v[20:21], v[18:19] op_sel_hi:[0,1,1] neg_lo:[0,0,1] neg_hi:[0,0,1]
    v_cvt_pk_bf16_f32 v172, v22, v23
    v_pk_fma_f32 v[18:19], v[16:17], v[22:23], v[20:21] op_sel_hi:[0,1,1] neg_lo:[0,0,1] neg_hi:[0,0,1]
    v_cvt_pk_bf16_f32 v173, v18, v19
    v_pk_fma_f32 v[20:21], v[16:17], v[18:19], v[22:23] op_sel_hi:[0,1,1] neg_lo:[0,0,1] neg_hi:[0,0,1]
    v_cvt_pk_bf16_f32 v174, v20, v21
    v_pk_fma_f32 v[22:23], v[16:17], v[20:21], v[18:19] op_sel_hi:[0,1,1] neg_lo:[0,0,1] neg_hi:[0,0,1]
    v_cvt_pk_bf16_f32 v175, v22, v23
    v_pk_fma_f32 v[18:19], v[16:17], v[22:23], v[20:21] op_sel_hi:[0,1,1] neg_lo:[0,0,1] neg_hi:[0,0,1]
    v_cvt_pk_bf16_f32 v176, v18, v19
    v_pk_fma_f32 v[20:21], v[16:17], v[18:19], v[22:23] op_sel_hi:[0,1,1] neg_lo:[0,0,1] neg_hi:[0,0,1]
    v_cvt_pk_bf16_f32 v177, v20, v21
    v_pk_fma_f32 v[22:23], v[16:17], v[20:21], v[18:19] op_sel_hi:[0,1,1] neg_lo:[0,0,1] neg_hi:[0,0,1]
    v_cvt_pk_bf16_f32 v178, v22, v23
    v_pk_fma_f32 v[18:19], v[16:17], v[22:23], v[20:21] op_sel_hi:[0,1,1] neg_lo:[0,0,1] neg_hi:[0,0,1]
    v_cvt_pk_bf16_f32 v179, v18, v19
    v_pk_fma_f32 v[20:21], v[16:17], v[18:19], v[22:23] op_sel_hi:[0,1,1] neg_lo:[0,0,1] neg_hi:[0,0,1]
    v_cvt_pk_bf16_f32 v180, v20, v21
    v_pk_fma_f32 v[22:23], v[16:17], v[20:21], v[18:19] op_sel_hi:[0,1,1] neg_lo:[0,0,1] neg_hi:[0,0,1]
    v_cvt_pk_bf16_f32 v181, v22, v23
    v_pk_fma_f32 v[18:19], v[16:17], v[22:23], v[20:21] op_sel_hi:[0,1,1] neg_lo:[0,0,1] neg_hi:[0,0,1]
    v_cvt_pk_bf16_f32 v182, v18, v19
    v_pk_fma_f32 v[20:21], v[16:17], v[18:19], v[22:23] op_sel_hi:[0,1,1] neg_lo:[0,0,1] neg_hi:[0,0,1]
    v_cvt_pk_bf16_f32 v183, v20, v21
    v_add_f32 v13, v13, v15
    v_fract_f32 v13, v13
    v_add_f32 v24, v13, v14
    v_cos_f32 v18, v13
    v_cos_f32 v19, v24
    v_add_f32 v25, v24, v14
    v_add_f32 v24, v25, v14
    v_cos_f32 v20, v25
    v_cos_f32 v21, v24
    v_cvt_pk_bf16_f32 v184, v18, v19
    s_nop 0
    v_cvt_pk_bf16_f32 v185, v20, v21
    v_pk_fma_f32 v[22:23], v[16:17], v[20:21], v[18:19] op_sel_hi:[0,1,1] neg_lo:[0,0,1] neg_hi:[0,0,1]
    v_cvt_pk_bf16_f32 v186, v22, v23
    v_pk_fma_f32 v[18:19], v[16:17], v[22:23], v[20:21] op_sel_hi:[0,1,1] neg_lo:[0,0,1] neg_hi:[0,0,1]
    v_cvt_pk_bf16_f32 v187, v18, v19
    v_pk_fma_f32 v[20:21], v[16:17], v[18:19], v[22:23] op_sel_hi:[0,1,1] neg_lo:[0,0,1] neg_hi:[0,0,1]
    v_cvt_pk_bf16_f32 v188, v20, v21
    v_pk_fma_f32 v[22:23], v[16:17], v[20:21], v[18:19] op_sel_hi:[0,1,1] neg_lo:[0,0,1] neg_hi:[0,0,1]
    v_cvt_pk_bf16_f32 v189, v22, v23
    v_pk_fma_f32 v[18:19], v[16:17], v[22:23], v[20:21] op_sel_hi:[0,1,1] neg_lo:[0,0,1] neg_hi:[0,0,1]
    v_cvt_pk_bf16_f32 v190, v18, v19
    v_pk_fma_f32 v[20:21], v[16:17], v[18:19], v[22:23] op_sel_hi:[0,1,1] neg_lo:[0,0,1] neg_hi:[0,0,1]
    v_cvt_pk_bf16_f32 v191, v20, v21
    v_pk_fma_f32 v[22:23], v[16:17], v[20:21], v[18:19] op_sel_hi:[0,1,1] neg_lo:[0,0,1] neg_hi:[0,0,1]
    v_cvt_pk_bf16_f32 v192, v22, v23
    v_pk_fma_f32 v[18:19], v[16:17], v[22:23], v[20:21] op_sel_hi:[0,1,1] neg_lo:[0,0,1] neg_hi:[0,0,1]
    v_cvt_pk_bf16_f32 v193, v18, v19
    v_pk_fma_f32 v[20:21], v[16:17], v[18:19], v[22:23] op_sel_hi:[0,1,1] neg_lo:[0,0,1] neg_hi:[0,0,1]
    v_cvt_pk_bf16_f32 v194, v20, v21
    v_pk_fma_f32 v[22:23], v[16:17], v[20:21], v[18:19] op_sel_hi:[0,1,1] neg_lo:[0,0,1] neg_hi:[0,0,1]
    v_cvt_pk_bf16_f32 v195, v22, v23
    v_pk_fma_f32 v[18:19], v[16:17], v[22:23], v[20:21] op_sel_hi:[0,1,1] neg_lo:[0,0,1] neg_hi:[0,0,1]
    v_cvt_pk_bf16_f32 v196, v18, v19
    v_pk_fma_f32 v[20:21], v[16:17], v[18:19], v[22:23] op_sel_hi:[0,1,1] neg_lo:[0,0,1] neg_hi:[0,0,1]
    v_cvt_pk_bf16_f32 v197, v20, v21
    v_pk_fma_f32 v[22:23], v[16:17], v[20:21], v[18:19] op_sel_hi:[0,1,1] neg_lo:[0,0,1] neg_hi:[0,0,1]
    v_cvt_pk_bf16_f32 v198, v22, v23
    v_pk_fma_f32 v[18:19], v[16:17], v[22:23], v[20:21] op_sel_hi:[0,1,1] neg_lo:[0,0,1] neg_hi:[0,0,1]
    v_cvt_pk_bf16_f32 v199, v18, v19
    v_pk_fma_f32 v[20:21], v[16:17], v[18:19], v[22:23] op_sel_hi:[0,1,1] neg_lo:[0,0,1] neg_hi:[0,0,1]
    v_cvt_pk_bf16_f32 v200, v20, v21
    v_pk_fma_f32 v[22:23], v[16:17], v[20:21], v[18:19] op_sel_hi:[0,1,1] neg_lo:[0,0,1] neg_hi:[0,0,1]
    v_cvt_pk_bf16_f32 v201, v22, v23
    v_pk_fma_f32 v[18:19], v[16:17], v[22:23], v[20:21] op_sel_hi:[0,1,1] neg_lo:[0,0,1] neg_hi:[0,0,1]
    v_cvt_pk_bf16_f32 v202, v18, v19
    v_pk_fma_f32 v[20:21], v[16:17], v[18:19], v[22:23] op_sel_hi:[0,1,1] neg_lo:[0,0,1] neg_hi:[0,0,1]
    v_cvt_pk_bf16_f32 v203, v20, v21
    v_add_f32 v13, v13, v15
    v_fract_f32 v13, v13
    v_add_f32 v24, v13, v14
    v_cos_f32 v18, v13
    v_cos_f32 v19, v24
    v_add_f32 v25, v24, v14
    v_add_f32 v24, v25, v14
    v_cos_f32 v20, v25
    v_cos_f32 v21, v24
    v_cvt_pk_bf16_f32 v204, v18, v19
    s_nop 0
    v_cvt_pk_bf16_f32 v205, v20, v21
    v_pk_fma_f32 v[22:23], v[16:17], v[20:21], v[18:19] op_sel_hi:[0,1,1] neg_lo:[0,0,1] neg_hi:[0,0,1]
    v_cvt_pk_bf16_f32 v206, v22, v23
    v_pk_fma_f32 v[18:19], v[16:17], v[22:23], v[20:21] op_sel_hi:[0,1,1] neg_lo:[0,0,1] neg_hi:[0,0,1]
    v_cvt_pk_bf16_f32 v207, v18, v19
    v_pk_fma_f32 v[20:21], v[16:17], v[18:19], v[22:23] op_sel_hi:[0,1,1] neg_lo:[0,0,1] neg_hi:[0,0,1]
    v_cvt_pk_bf16_f32 v208, v20, v21
    v_pk_fma_f32 v[22:23], v[16:17], v[20:21], v[18:19] op_sel_hi:[0,1,1] neg_lo:[0,0,1] neg_hi:[0,0,1]
    v_cvt_pk_bf16_f32 v209, v22, v23
    v_pk_fma_f32 v[18:19], v[16:17], v[22:23], v[20:21] op_sel_hi:[0,1,1] neg_lo:[0,0,1] neg_hi:[0,0,1]
    v_cvt_pk_bf16_f32 v210, v18, v19
    v_pk_fma_f32 v[20:21], v[16:17], v[18:19], v[22:23] op_sel_hi:[0,1,1] neg_lo:[0,0,1] neg_hi:[0,0,1]
    v_cvt_pk_bf16_f32 v211, v20, v21
    v_pk_fma_f32 v[22:23], v[16:17], v[20:21], v[18:19] op_sel_hi:[0,1,1] neg_lo:[0,0,1] neg_hi:[0,0,1]
    v_cvt_pk_bf16_f32 v212, v22, v23
    v_pk_fma_f32 v[18:19], v[16:17], v[22:23], v[20:21] op_sel_hi:[0,1,1] neg_lo:[0,0,1] neg_hi:[0,0,1]
    v_cvt_pk_bf16_f32 v213, v18, v19
    v_pk_fma_f32 v[20:21], v[16:17], v[18:19], v[22:23] op_sel_hi:[0,1,1] neg_lo:[0,0,1] neg_hi:[0,0,1]
    v_cvt_pk_bf16_f32 v214, v20, v21
    v_pk_fma_f32 v[22:23], v[16:17], v[20:21], v[18:19] op_sel_hi:[0,1,1] neg_lo:[0,0,1] neg_hi:[0,0,1]
    v_cvt_pk_bf16_f32 v215, v22, v23
    v_pk_fma_f32 v[18:19], v[16:17], v[22:23], v[20:21] op_sel_hi:[0,1,1] neg_lo:[0,0,1] neg_hi:[0,0,1]
    v_cvt_pk_bf16_f32 v216, v18, v19
    v_pk_fma_f32 v[20:21], v[16:17], v[18:19], v[22:23] op_sel_hi:[0,1,1] neg_lo:[0,0,1] neg_hi:[0,0,1]
    v_cvt_pk_bf16_f32 v217, v20, v21
    v_pk_fma_f32 v[22:23], v[16:17], v[20:21], v[18:19] op_sel_hi:[0,1,1] neg_lo:[0,0,1] neg_hi:[0,0,1]
    v_cvt_pk_bf16_f32 v218, v22, v23
    v_pk_fma_f32 v[18:19], v[16:17], v[22:23], v[20:21] op_sel_hi:[0,1,1] neg_lo:[0,0,1] neg_hi:[0,0,1]
    v_cvt_pk_bf16_f32 v219, v18, v19
    v_pk_fma_f32 v[20:21], v[16:17], v[18:19], v[22:23] op_sel_hi:[0,1,1] neg_lo:[0,0,1] neg_hi:[0,0,1]
    v_cvt_pk_bf16_f32 v220, v20, v21
    v_pk_fma_f32 v[22:23], v[16:17], v[20:21], v[18:19] op_sel_hi:[0,1,1] neg_lo:[0,0,1] neg_hi:[0,0,1]
    v_cvt_pk_bf16_f32 v221, v22, v23
    v_pk_fma_f32 v[18:19], v[16:17], v[22:23], v[20:21] op_sel_hi:[0,1,1] neg_lo:[0,0,1] neg_hi:[0,0,1]
    v_cvt_pk_bf16_f32 v222, v18, v19
    v_pk_fma_f32 v[20:21], v[16:17], v[18:19], v[22:23] op_sel_hi:[0,1,1] neg_lo:[0,0,1] neg_hi:[0,0,1]
    v_cvt_pk_bf16_f32 v223, v20, v21
    v_add_f32 v13, v13, v15
    v_fract_f32 v13, v13
    s_barrier
    v_add_f32 v24, v13, v14
    v_cos_f32 v18, v13
    v_cos_f32 v19, v24
    v_add_f32 v25, v24, v14
    v_add_f32 v24, v25, v14
    v_cos_f32 v20, v25
    v_cos_f32 v21, v24
    v_cvt_pk_bf16_f32 v224, v18, v19
    s_nop 0
    v_cvt_pk_bf16_f32 v225, v20, v21
    v_pk_fma_f32 v[22:23], v[16:17], v[20:21], v[18:19] op_sel_hi:[0,1,1] neg_lo:[0,0,1] neg_hi:[0,0,1]
    v_cvt_pk_bf16_f32 v226, v22, v23
    v_pk_fma_f32 v[18:19], v[16:17], v[22:23], v[20:21] op_sel_hi:[0,1,1] neg_lo:[0,0,1] neg_hi:[0,0,1]
    v_cvt_pk_bf16_f32 v227, v18, v19
    v_pk_fma_f32 v[20:21], v[16:17], v[18:19], v[22:23] op_sel_hi:[0,1,1] neg_lo:[0,0,1] neg_hi:[0,0,1]
    v_cvt_pk_bf16_f32 v228, v20, v21
    v_pk_fma_f32 v[22:23], v[16:17], v[20:21], v[18:19] op_sel_hi:[0,1,1] neg_lo:[0,0,1] neg_hi:[0,0,1]
    v_cvt_pk_bf16_f32 v229, v22, v23
    v_pk_fma_f32 v[18:19], v[16:17], v[22:23], v[20:21] op_sel_hi:[0,1,1] neg_lo:[0,0,1] neg_hi:[0,0,1]
    v_cvt_pk_bf16_f32 v230, v18, v19
    v_pk_fma_f32 v[20:21], v[16:17], v[18:19], v[22:23] op_sel_hi:[0,1,1] neg_lo:[0,0,1] neg_hi:[0,0,1]
    v_cvt_pk_bf16_f32 v231, v20, v21
    v_pk_fma_f32 v[22:23], v[16:17], v[20:21], v[18:19] op_sel_hi:[0,1,1] neg_lo:[0,0,1] neg_hi:[0,0,1]
    v_cvt_pk_bf16_f32 v232, v22, v23
    v_pk_fma_f32 v[18:19], v[16:17], v[22:23], v[20:21] op_sel_hi:[0,1,1] neg_lo:[0,0,1] neg_hi:[0,0,1]
    v_cvt_pk_bf16_f32 v233, v18, v19
    v_pk_fma_f32 v[20:21], v[16:17], v[18:19], v[22:23] op_sel_hi:[0,1,1] neg_lo:[0,0,1] neg_hi:[0,0,1]
    v_cvt_pk_bf16_f32 v234, v20, v21
    v_pk_fma_f32 v[22:23], v[16:17], v[20:21], v[18:19] op_sel_hi:[0,1,1] neg_lo:[0,0,1] neg_hi:[0,0,1]
    v_cvt_pk_bf16_f32 v235, v22, v23
    v_pk_fma_f32 v[18:19], v[16:17], v[22:23], v[20:21] op_sel_hi:[0,1,1] neg_lo:[0,0,1] neg_hi:[0,0,1]
    v_cvt_pk_bf16_f32 v236, v18, v19
    v_pk_fma_f32 v[20:21], v[16:17], v[18:19], v[22:23] op_sel_hi:[0,1,1] neg_lo:[0,0,1] neg_hi:[0,0,1]
    v_cvt_pk_bf16_f32 v237, v20, v21
    v_pk_fma_f32 v[22:23], v[16:17], v[20:21], v[18:19] op_sel_hi:[0,1,1] neg_lo:[0,0,1] neg_hi:[0,0,1]
    v_cvt_pk_bf16_f32 v238, v22, v23
    v_pk_fma_f32 v[18:19], v[16:17], v[22:23], v[20:21] op_sel_hi:[0,1,1] neg_lo:[0,0,1] neg_hi:[0,0,1]
    v_cvt_pk_bf16_f32 v239, v18, v19
    v_pk_fma_f32 v[20:21], v[16:17], v[18:19], v[22:23] op_sel_hi:[0,1,1] neg_lo:[0,0,1] neg_hi:[0,0,1]
    v_cvt_pk_bf16_f32 v240, v20, v21
    v_pk_fma_f32 v[22:23], v[16:17], v[20:21], v[18:19] op_sel_hi:[0,1,1] neg_lo:[0,0,1] neg_hi:[0,0,1]
    v_cvt_pk_bf16_f32 v241, v22, v23
    v_pk_fma_f32 v[18:19], v[16:17], v[22:23], v[20:21] op_sel_hi:[0,1,1] neg_lo:[0,0,1] neg_hi:[0,0,1]
    v_cvt_pk_bf16_f32 v242, v18, v19
    v_pk_fma_f32 v[20:21], v[16:17], v[18:19], v[22:23] op_sel_hi:[0,1,1] neg_lo:[0,0,1] neg_hi:[0,0,1]
    v_mul_f32 v21, 0.5, v21
    v_cvt_pk_bf16_f32 v243, v20, v21
    v_bfe_u32 v2, v1, 2, 2
    v_lshrrev_b32 v3, 5, v1
    v_lshlrev_b32 v3, 3, v3
    v_bfe_u32 v4, v1, 4, 1
    v_lshl_or_b32 v3, v4, 1, v3
    v_bfe_u32 v4, v1, 1, 1
    v_or_b32 v3, v3, v4
    v_lshlrev_b32 v4, 2, v2
    v_xor_b32 v3, v3, v4
    v_lshlrev_b32 v3, 4, v3
    v_lshl_add_u32 v3, v2, 8, v3
    v_and_b32 v4, 1, v1
    v_lshl_add_u32 v7, v4, 3, v3
    v_xor_b32 v8, 64, v7
    v_add_u32 v9, 40960, v7
    v_add_u32 v10, 40960, v8
    v_lshrrev_b32 v3, 5, v1
    s_lshl_b32 s24, s16, 2
    v_add_u32 v3, s24, v3
    v_xor_b32 v3, v3, v1
    v_and_b32 v3, 15, v3
    v_lshlrev_b32 v3, 4, v3
    v_and_b32 v4, 31, v1
    v_lshl_add_u32 v3, v4, 8, v3
    v_add_u32 v11, 81920, v3
    v_lshlrev_b32 v12, 4, v1
    s_mul_i32 s24, s17, 81920
    s_lshl_b32 s25, s26, 11
    s_add_u32 s24, s24, s25
    s_add_u32 s24, s24, 7864320
    s_barrier
    ds_read_b64_tr_b16 v[28:29], v7 offset:0
    ds_read_b64_tr_b16 v[30:31], v7 offset:1024
    ds_read_b64_tr_b16 v[32:33], v8 offset:0
    ds_read_b64_tr_b16 v[34:35], v8 offset:1024
    ds_read_b64_tr_b16 v[36:37], v7 offset:2048
    ds_read_b64_tr_b16 v[38:39], v7 offset:3072
    ds_read_b64_tr_b16 v[40:41], v8 offset:2048
    ds_read_b64_tr_b16 v[42:43], v8 offset:3072
    v_and_b32 v6, 31, v1
    v_lshlrev_b32 v6, 2, v6
    s_lshl_b32 s22, s17, 8
    s_add_u32 s22, s22, 16777216
    buffer_load_dword v5, v6, s[12:15], s22 offen
    buffer_load_dword v6, v6, s[12:15], s22 offen offset:128
    ds_read_b64_tr_b16 v[44:45], v7 offset:4096
    ds_read_b64_tr_b16 v[46:47], v7 offset:5120
    ds_read_b64_tr_b16 v[48:49], v8 offset:4096
    ds_read_b64_tr_b16 v[50:51], v8 offset:5120
    s_waitcnt lgkmcnt(8)
    v_mfma_f32_32x32x16_bf16 v[52:67], v[84:87], v[28:31], 0
    v_mfma_f32_32x32x16_bf16 v[68:83], v[84:87], v[32:35], 0
    ds_read_b64_tr_b16 v[28:29], v7 offset:6144
    ds_read_b64_tr_b16 v[30:31], v7 offset:7168
    ds_read_b64_tr_b16 v[32:33], v8 offset:6144
    ds_read_b64_tr_b16 v[34:35], v8 offset:7168
    s_waitcnt lgkmcnt(8)
    v_mfma_f32_32x32x16_bf16 v[52:67], v[88:91], v[36:39], v[52:67]
    v_mfma_f32_32x32x16_bf16 v[68:83], v[88:91], v[40:43], v[68:83]
    ds_read_b64_tr_b16 v[36:37], v7 offset:8192
    ds_read_b64_tr_b16 v[38:39], v7 offset:9216
    ds_read_b64_tr_b16 v[40:41], v8 offset:8192
    ds_read_b64_tr_b16 v[42:43], v8 offset:9216
    s_waitcnt lgkmcnt(8)
    v_mfma_f32_32x32x16_bf16 v[52:67], v[92:95], v[44:47], v[52:67]
    v_mfma_f32_32x32x16_bf16 v[68:83], v[92:95], v[48:51], v[68:83]
    ds_read_b64_tr_b16 v[44:45], v7 offset:10240
    ds_read_b64_tr_b16 v[46:47], v7 offset:11264
    ds_read_b64_tr_b16 v[48:49], v8 offset:10240
    ds_read_b64_tr_b16 v[50:51], v8 offset:11264
    s_waitcnt lgkmcnt(8)
    v_mfma_f32_32x32x16_bf16 v[52:67], v[96:99], v[28:31], v[52:67]
    v_mfma_f32_32x32x16_bf16 v[68:83], v[96:99], v[32:35], v[68:83]
    ds_read_b64_tr_b16 v[28:29], v7 offset:12288
    ds_read_b64_tr_b16 v[30:31], v7 offset:13312
    ds_read_b64_tr_b16 v[32:33], v8 offset:12288
    ds_read_b64_tr_b16 v[34:35], v8 offset:13312
    s_waitcnt lgkmcnt(8)
    v_mfma_f32_32x32x16_bf16 v[52:67], v[100:103], v[36:39], v[52:67]
    v_mfma_f32_32x32x16_bf16 v[68:83], v[100:103], v[40:43], v[68:83]
    ds_read_b64_tr_b16 v[36:37], v7 offset:14336
    ds_read_b64_tr_b16 v[38:39], v7 offset:15360
    ds_read_b64_tr_b16 v[40:41], v8 offset:14336
    ds_read_b64_tr_b16 v[42:43], v8 offset:15360
    s_waitcnt lgkmcnt(8)
    v_mfma_f32_32x32x16_bf16 v[52:67], v[104:107], v[44:47], v[52:67]
    v_mfma_f32_32x32x16_bf16 v[68:83], v[104:107], v[48:51], v[68:83]
    s_barrier
    ds_read_b64_tr_b16 v[44:45], v7 offset:16384
    ds_read_b64_tr_b16 v[46:47], v7 offset:17408
    ds_read_b64_tr_b16 v[48:49], v8 offset:16384
    ds_read_b64_tr_b16 v[50:51], v8 offset:17408
    s_waitcnt lgkmcnt(8)
    v_mfma_f32_32x32x16_bf16 v[52:67], v[108:111], v[28:31], v[52:67]
    v_mfma_f32_32x32x16_bf16 v[68:83], v[108:111], v[32:35], v[68:83]
    ds_read_b64_tr_b16 v[28:29], v7 offset:18432
    ds_read_b64_tr_b16 v[30:31], v7 offset:19456
    ds_read_b64_tr_b16 v[32:33], v8 offset:18432
    ds_read_b64_tr_b16 v[34:35], v8 offset:19456
    s_waitcnt lgkmcnt(8)
    v_mfma_f32_32x32x16_bf16 v[52:67], v[112:115], v[36:39], v[52:67]
    v_mfma_f32_32x32x16_bf16 v[68:83], v[112:115], v[40:43], v[68:83]
    ds_read_b64_tr_b16 v[36:37], v7 offset:20480
    ds_read_b64_tr_b16 v[38:39], v7 offset:21504
    ds_read_b64_tr_b16 v[40:41], v8 offset:20480
    ds_read_b64_tr_b16 v[42:43], v8 offset:21504
    s_waitcnt lgkmcnt(8)
    v_mfma_f32_32x32x16_bf16 v[52:67], v[116:119], v[44:47], v[52:67]
    v_mfma_f32_32x32x16_bf16 v[68:83], v[116:119], v[48:51], v[68:83]
    ds_read_b64_tr_b16 v[44:45], v7 offset:22528
    ds_read_b64_tr_b16 v[46:47], v7 offset:23552
    ds_read_b64_tr_b16 v[48:49], v8 offset:22528
    ds_read_b64_tr_b16 v[50:51], v8 offset:23552
    s_waitcnt lgkmcnt(8)
    v_mfma_f32_32x32x16_bf16 v[52:67], v[120:123], v[28:31], v[52:67]
    v_mfma_f32_32x32x16_bf16 v[68:83], v[120:123], v[32:35], v[68:83]
    ds_read_b64_tr_b16 v[28:29], v7 offset:24576
    ds_read_b64_tr_b16 v[30:31], v7 offset:25600
    ds_read_b64_tr_b16 v[32:33], v8 offset:24576
    ds_read_b64_tr_b16 v[34:35], v8 offset:25600
    s_waitcnt lgkmcnt(8)
    v_mfma_f32_32x32x16_bf16 v[52:67], v[124:127], v[36:39], v[52:67]
    v_mfma_f32_32x32x16_bf16 v[68:83], v[124:127], v[40:43], v[68:83]
    ds_read_b64_tr_b16 v[36:37], v7 offset:26624
    ds_read_b64_tr_b16 v[38:39], v7 offset:27648
    ds_read_b64_tr_b16 v[40:41], v8 offset:26624
    ds_read_b64_tr_b16 v[42:43], v8 offset:27648
    s_waitcnt lgkmcnt(8)
    v_mfma_f32_32x32x16_bf16 v[52:67], v[128:131], v[44:47], v[52:67]
    v_mfma_f32_32x32x16_bf16 v[68:83], v[128:131], v[48:51], v[68:83]
    ds_read_b64_tr_b16 v[44:45], v7 offset:28672
    ds_read_b64_tr_b16 v[46:47], v7 offset:29696
    ds_read_b64_tr_b16 v[48:49], v8 offset:28672
    ds_read_b64_tr_b16 v[50:51], v8 offset:29696
    s_waitcnt lgkmcnt(8)
    v_mfma_f32_32x32x16_bf16 v[52:67], v[132:135], v[28:31], v[52:67]
    v_mfma_f32_32x32x16_bf16 v[68:83], v[132:135], v[32:35], v[68:83]
    ds_read_b64_tr_b16 v[28:29], v7 offset:30720
    ds_read_b64_tr_b16 v[30:31], v7 offset:31744
    ds_read_b64_tr_b16 v[32:33], v8 offset:30720
    ds_read_b64_tr_b16 v[34:35], v8 offset:31744
    s_waitcnt lgkmcnt(8)
    v_mfma_f32_32x32x16_bf16 v[52:67], v[136:139], v[36:39], v[52:67]
    v_mfma_f32_32x32x16_bf16 v[68:83], v[136:139], v[40:43], v[68:83]
    s_barrier
    ds_read_b64_tr_b16 v[36:37], v7 offset:32768
    ds_read_b64_tr_b16 v[38:39], v7 offset:33792
    ds_read_b64_tr_b16 v[40:41], v8 offset:32768
    ds_read_b64_tr_b16 v[42:43], v8 offset:33792
    s_waitcnt lgkmcnt(8)
    v_mfma_f32_32x32x16_bf16 v[52:67], v[140:143], v[44:47], v[52:67]
    v_mfma_f32_32x32x16_bf16 v[68:83], v[140:143], v[48:51], v[68:83]
    ds_read_b64_tr_b16 v[44:45], v7 offset:34816
    ds_read_b64_tr_b16 v[46:47], v7 offset:35840
    ds_read_b64_tr_b16 v[48:49], v8 offset:34816
    ds_read_b64_tr_b16 v[50:51], v8 offset:35840
    s_waitcnt lgkmcnt(8)
    v_mfma_f32_32x32x16_bf16 v[52:67], v[144:147], v[28:31], v[52:67]
    v_mfma_f32_32x32x16_bf16 v[68:83], v[144:147], v[32:35], v[68:83]
    ds_read_b64_tr_b16 v[28:29], v7 offset:36864
    ds_read_b64_tr_b16 v[30:31], v7 offset:37888
    ds_read_b64_tr_b16 v[32:33], v8 offset:36864
    ds_read_b64_tr_b16 v[34:35], v8 offset:37888
    s_waitcnt lgkmcnt(8)
    v_mfma_f32_32x32x16_bf16 v[52:67], v[148:151], v[36:39], v[52:67]
    v_mfma_f32_32x32x16_bf16 v[68:83], v[148:151], v[40:43], v[68:83]
    ds_read_b64_tr_b16 v[36:37], v7 offset:38912
    ds_read_b64_tr_b16 v[38:39], v7 offset:39936
    ds_read_b64_tr_b16 v[40:41], v8 offset:38912
    ds_read_b64_tr_b16 v[42:43], v8 offset:39936
    s_waitcnt lgkmcnt(8)
    v_mfma_f32_32x32x16_bf16 v[52:67], v[152:155], v[44:47], v[52:67]
    v_mfma_f32_32x32x16_bf16 v[68:83], v[152:155], v[48:51], v[68:83]
    ds_read_b64_tr_b16 v[44:45], v9 offset:0
    ds_read_b64_tr_b16 v[46:47], v9 offset:1024
    ds_read_b64_tr_b16 v[48:49], v10 offset:0
    ds_read_b64_tr_b16 v[50:51], v10 offset:1024
    s_waitcnt lgkmcnt(8)
    v_mfma_f32_32x32x16_bf16 v[52:67], v[156:159], v[28:31], v[52:67]
    v_mfma_f32_32x32x16_bf16 v[68:83], v[156:159], v[32:35], v[68:83]
    ds_read_b64_tr_b16 v[28:29], v9 offset:2048
    ds_read_b64_tr_b16 v[30:31], v9 offset:3072
    ds_read_b64_tr_b16 v[32:33], v10 offset:2048
    ds_read_b64_tr_b16 v[34:35], v10 offset:3072
    s_waitcnt lgkmcnt(8)
    v_mfma_f32_32x32x16_bf16 v[52:67], v[160:163], v[36:39], v[52:67]
    v_mfma_f32_32x32x16_bf16 v[68:83], v[160:163], v[40:43], v[68:83]
    ds_read_b64_tr_b16 v[36:37], v9 offset:4096
    ds_read_b64_tr_b16 v[38:39], v9 offset:5120
    ds_read_b64_tr_b16 v[40:41], v10 offset:4096
    ds_read_b64_tr_b16 v[42:43], v10 offset:5120
    s_waitcnt lgkmcnt(8)
    v_mfma_f32_32x32x16_bf16 v[52:67], v[164:167], v[44:47], v[52:67]
    v_mfma_f32_32x32x16_bf16 v[68:83], v[164:167], v[48:51], v[68:83]
    ds_read_b64_tr_b16 v[44:45], v9 offset:6144
    ds_read_b64_tr_b16 v[46:47], v9 offset:7168
    ds_read_b64_tr_b16 v[48:49], v10 offset:6144
    ds_read_b64_tr_b16 v[50:51], v10 offset:7168
    s_waitcnt lgkmcnt(8)
    v_mfma_f32_32x32x16_bf16 v[52:67], v[168:171], v[28:31], v[52:67]
    v_mfma_f32_32x32x16_bf16 v[68:83], v[168:171], v[32:35], v[68:83]
    s_barrier
    ds_read_b64_tr_b16 v[28:29], v9 offset:8192
    ds_read_b64_tr_b16 v[30:31], v9 offset:9216
    ds_read_b64_tr_b16 v[32:33], v10 offset:8192
    ds_read_b64_tr_b16 v[34:35], v10 offset:9216
    s_waitcnt lgkmcnt(8)
    v_mfma_f32_32x32x16_bf16 v[52:67], v[172:175], v[36:39], v[52:67]
    v_mfma_f32_32x32x16_bf16 v[68:83], v[172:175], v[40:43], v[68:83]
    ds_read_b64_tr_b16 v[36:37], v9 offset:10240
    ds_read_b64_tr_b16 v[38:39], v9 offset:11264
    ds_read_b64_tr_b16 v[40:41], v10 offset:10240
    ds_read_b64_tr_b16 v[42:43], v10 offset:11264
    s_waitcnt lgkmcnt(8)
    v_mfma_f32_32x32x16_bf16 v[52:67], v[176:179], v[44:47], v[52:67]
    v_mfma_f32_32x32x16_bf16 v[68:83], v[176:179], v[48:51], v[68:83]
    ds_read_b64_tr_b16 v[44:45], v9 offset:12288
    ds_read_b64_tr_b16 v[46:47], v9 offset:13312
    ds_read_b64_tr_b16 v[48:49], v10 offset:12288
    ds_read_b64_tr_b16 v[50:51], v10 offset:13312
    s_waitcnt lgkmcnt(8)
    v_mfma_f32_32x32x16_bf16 v[52:67], v[180:183], v[28:31], v[52:67]
    v_mfma_f32_32x32x16_bf16 v[68:83], v[180:183], v[32:35], v[68:83]
    ds_read_b64_tr_b16 v[28:29], v9 offset:14336
    ds_read_b64_tr_b16 v[30:31], v9 offset:15360
    ds_read_b64_tr_b16 v[32:33], v10 offset:14336
    ds_read_b64_tr_b16 v[34:35], v10 offset:15360
    s_waitcnt lgkmcnt(8)
    v_mfma_f32_32x32x16_bf16 v[52:67], v[184:187], v[36:39], v[52:67]
    v_mfma_f32_32x32x16_bf16 v[68:83], v[184:187], v[40:43], v[68:83]
    ds_read_b64_tr_b16 v[36:37], v9 offset:16384
    ds_read_b64_tr_b16 v[38:39], v9 offset:17408
    ds_read_b64_tr_b16 v[40:41], v10 offset:16384
    ds_read_b64_tr_b16 v[42:43], v10 offset:17408
    s_waitcnt lgkmcnt(8)
    v_mfma_f32_32x32x16_bf16 v[52:67], v[188:191], v[44:47], v[52:67]
    v_mfma_f32_32x32x16_bf16 v[68:83], v[188:191], v[48:51], v[68:83]
    ds_read_b64_tr_b16 v[44:45], v9 offset:18432
    ds_read_b64_tr_b16 v[46:47], v9 offset:19456
    ds_read_b64_tr_b16 v[48:49], v10 offset:18432
    ds_read_b64_tr_b16 v[50:51], v10 offset:19456
    s_waitcnt lgkmcnt(8)
    v_mfma_f32_32x32x16_bf16 v[52:67], v[192:195], v[28:31], v[52:67]
    v_mfma_f32_32x32x16_bf16 v[68:83], v[192:195], v[32:35], v[68:83]
    ds_read_b64_tr_b16 v[28:29], v9 offset:20480
    ds_read_b64_tr_b16 v[30:31], v9 offset:21504
    ds_read_b64_tr_b16 v[32:33], v10 offset:20480
    ds_read_b64_tr_b16 v[34:35], v10 offset:21504
    s_waitcnt lgkmcnt(8)
    v_mfma_f32_32x32x16_bf16 v[52:67], v[196:199], v[36:39], v[52:67]
    v_mfma_f32_32x32x16_bf16 v[68:83], v[196:199], v[40:43], v[68:83]
    ds_read_b64_tr_b16 v[36:37], v9 offset:22528
    ds_read_b64_tr_b16 v[38:39], v9 offset:23552
    ds_read_b64_tr_b16 v[40:41], v10 offset:22528
    ds_read_b64_tr_b16 v[42:43], v10 offset:23552
    s_waitcnt lgkmcnt(8)
    v_mfma_f32_32x32x16_bf16 v[52:67], v[200:203], v[44:47], v[52:67]
    v_mfma_f32_32x32x16_bf16 v[68:83], v[200:203], v[48:51], v[68:83]
    s_barrier
    ds_read_b64_tr_b16 v[44:45], v9 offset:24576
    ds_read_b64_tr_b16 v[46:47], v9 offset:25600
    ds_read_b64_tr_b16 v[48:49], v10 offset:24576
    ds_read_b64_tr_b16 v[50:51], v10 offset:25600
    s_waitcnt lgkmcnt(8)
    v_mfma_f32_32x32x16_bf16 v[52:67], v[204:207], v[28:31], v[52:67]
    v_mfma_f32_32x32x16_bf16 v[68:83], v[204:207], v[32:35], v[68:83]
    ds_read_b64_tr_b16 v[28:29], v9 offset:26624
    ds_read_b64_tr_b16 v[30:31], v9 offset:27648
    ds_read_b64_tr_b16 v[32:33], v10 offset:26624
    ds_read_b64_tr_b16 v[34:35], v10 offset:27648
    s_waitcnt lgkmcnt(8)
    v_mfma_f32_32x32x16_bf16 v[52:67], v[208:211], v[36:39], v[52:67]
    v_mfma_f32_32x32x16_bf16 v[68:83], v[208:211], v[40:43], v[68:83]
    ds_read_b64_tr_b16 v[36:37], v9 offset:28672
    ds_read_b64_tr_b16 v[38:39], v9 offset:29696
    ds_read_b64_tr_b16 v[40:41], v10 offset:28672
    ds_read_b64_tr_b16 v[42:43], v10 offset:29696
    s_waitcnt lgkmcnt(8)
    v_mfma_f32_32x32x16_bf16 v[52:67], v[212:215], v[44:47], v[52:67]
    v_mfma_f32_32x32x16_bf16 v[68:83], v[212:215], v[48:51], v[68:83]
    ds_read_b64_tr_b16 v[44:45], v9 offset:30720
    ds_read_b64_tr_b16 v[46:47], v9 offset:31744
    ds_read_b64_tr_b16 v[48:49], v10 offset:30720
    ds_read_b64_tr_b16 v[50:51], v10 offset:31744
    s_waitcnt lgkmcnt(8)
    v_mfma_f32_32x32x16_bf16 v[52:67], v[216:219], v[28:31], v[52:67]
    v_mfma_f32_32x32x16_bf16 v[68:83], v[216:219], v[32:35], v[68:83]
    ds_read_b64_tr_b16 v[28:29], v9 offset:32768
    ds_read_b64_tr_b16 v[30:31], v9 offset:33792
    ds_read_b64_tr_b16 v[32:33], v10 offset:32768
    ds_read_b64_tr_b16 v[34:35], v10 offset:33792
    s_waitcnt lgkmcnt(8)
    v_mfma_f32_32x32x16_bf16 v[52:67], v[220:223], v[36:39], v[52:67]
    v_mfma_f32_32x32x16_bf16 v[68:83], v[220:223], v[40:43], v[68:83]
    ds_read_b64_tr_b16 v[36:37], v9 offset:34816
    ds_read_b64_tr_b16 v[38:39], v9 offset:35840
    ds_read_b64_tr_b16 v[40:41], v10 offset:34816
    ds_read_b64_tr_b16 v[42:43], v10 offset:35840
    s_waitcnt lgkmcnt(8)
    v_mfma_f32_32x32x16_bf16 v[52:67], v[224:227], v[44:47], v[52:67]
    v_mfma_f32_32x32x16_bf16 v[68:83], v[224:227], v[48:51], v[68:83]
    ds_read_b64_tr_b16 v[44:45], v9 offset:36864
    ds_read_b64_tr_b16 v[46:47], v9 offset:37888
    ds_read_b64_tr_b16 v[48:49], v10 offset:36864
    ds_read_b64_tr_b16 v[50:51], v10 offset:37888
    s_waitcnt lgkmcnt(8)
    v_mfma_f32_32x32x16_bf16 v[52:67], v[228:231], v[28:31], v[52:67]
    v_mfma_f32_32x32x16_bf16 v[68:83], v[228:231], v[32:35], v[68:83]
    ds_read_b64_tr_b16 v[28:29], v9 offset:38912
    ds_read_b64_tr_b16 v[30:31], v9 offset:39936
    ds_read_b64_tr_b16 v[32:33], v10 offset:38912
    ds_read_b64_tr_b16 v[34:35], v10 offset:39936
    s_waitcnt lgkmcnt(8)
    v_mfma_f32_32x32x16_bf16 v[52:67], v[232:235], v[36:39], v[52:67]
    v_mfma_f32_32x32x16_bf16 v[68:83], v[232:235], v[40:43], v[68:83]
    s_waitcnt lgkmcnt(4)
    v_mfma_f32_32x32x16_bf16 v[52:67], v[236:239], v[44:47], v[52:67]
    v_mfma_f32_32x32x16_bf16 v[68:83], v[236:239], v[48:51], v[68:83]
    s_waitcnt lgkmcnt(0)
    v_mfma_f32_32x32x16_bf16 v[52:67], v[240:243], v[28:31], v[52:67]
    v_mfma_f32_32x32x16_bf16 v[68:83], v[240:243], v[32:35], v[68:83]
    s_waitcnt vmcnt(0)
    s_barrier
    v_xor_b32 v148, 32, v11
    ds_read_b128 v[84:87], v11 offset:0
    ds_read_b128 v[88:91], v148 offset:0
    ds_read_b128 v[92:95], v11 offset:8192
    ds_read_b128 v[96:99], v148 offset:8192
    v_mov_b32 v150, 0x35cccccd
    v_xor_b32 v152, 0x80000000, v5
    v_xor_b32 v154, 0x80000000, v6
    s_waitcnt lgkmcnt(0)
    v_lshlrev_b32 v100, 16, v84
    v_and_b32 v101, 0xffff0000, v84
    v_lshlrev_b32 v102, 16, v85
    v_and_b32 v103, 0xffff0000, v85
    v_lshlrev_b32 v104, 16, v86
    v_and_b32 v105, 0xffff0000, v86
    v_lshlrev_b32 v106, 16, v87
    v_and_b32 v107, 0xffff0000, v87
    v_pk_add_f32 v[100:101], v[100:101], v[152:153] op_sel_hi:[1,0]
    v_pk_add_f32 v[102:103], v[102:103], v[152:153] op_sel_hi:[1,0]
    v_pk_add_f32 v[104:105], v[104:105], v[152:153] op_sel_hi:[1,0]
    v_pk_add_f32 v[106:107], v[106:107], v[152:153] op_sel_hi:[1,0]
    v_pk_fma_f32 v[100:101], v[52:53], v[150:151], v[100:101] op_sel_hi:[1,0,1]
    v_pk_fma_f32 v[102:103], v[54:55], v[150:151], v[102:103] op_sel_hi:[1,0,1]
    v_pk_fma_f32 v[104:105], v[56:57], v[150:151], v[104:105] op_sel_hi:[1,0,1]
    v_pk_fma_f32 v[106:107], v[58:59], v[150:151], v[106:107] op_sel_hi:[1,0,1]
    v_cvt_pk_bf16_f32 v132, v100, v101
    v_cvt_pk_bf16_f32 v133, v102, v103
    v_cvt_pk_bf16_f32 v134, v104, v105
    v_cvt_pk_bf16_f32 v135, v106, v107
    s_add_u32 s25, s24, 0
    buffer_store_dwordx4 v[132:135], v12, s[12:15], s25 offen sc1
    v_pk_mul_f32 v[156:157], v[100:101], v[100:101]
    v_pk_fma_f32 v[156:157], v[102:103], v[102:103], v[156:157]
    v_pk_fma_f32 v[156:157], v[104:105], v[104:105], v[156:157]
    v_pk_fma_f32 v[156:157], v[106:107], v[106:107], v[156:157]
    v_lshlrev_b32 v108, 16, v88
    v_and_b32 v109, 0xffff0000, v88
    v_lshlrev_b32 v110, 16, v89
    v_and_b32 v111, 0xffff0000, v89
    v_lshlrev_b32 v112, 16, v90
    v_and_b32 v113, 0xffff0000, v90
    v_lshlrev_b32 v114, 16, v91
    v_and_b32 v115, 0xffff0000, v91
    v_pk_add_f32 v[108:109], v[108:109], v[152:153] op_sel_hi:[1,0]
    v_pk_add_f32 v[110:111], v[110:111], v[152:153] op_sel_hi:[1,0]
    v_pk_add_f32 v[112:113], v[112:113], v[152:153] op_sel_hi:[1,0]
    v_pk_add_f32 v[114:115], v[114:115], v[152:153] op_sel_hi:[1,0]
    v_pk_fma_f32 v[108:109], v[60:61], v[150:151], v[108:109] op_sel_hi:[1,0,1]
    v_pk_fma_f32 v[110:111], v[62:63], v[150:151], v[110:111] op_sel_hi:[1,0,1]
    v_pk_fma_f32 v[112:113], v[64:65], v[150:151], v[112:113] op_sel_hi:[1,0,1]
    v_pk_fma_f32 v[114:115], v[66:67], v[150:151], v[114:115] op_sel_hi:[1,0,1]
    v_cvt_pk_bf16_f32 v136, v108, v109
    v_cvt_pk_bf16_f32 v137, v110, v111
    v_cvt_pk_bf16_f32 v138, v112, v113
    v_cvt_pk_bf16_f32 v139, v114, v115
    s_add_u32 s25, s24, 1024
    buffer_store_dwordx4 v[136:139], v12, s[12:15], s25 offen sc1
    v_pk_fma_f32 v[156:157], v[108:109], v[108:109], v[156:157]
    v_pk_fma_f32 v[156:157], v[110:111], v[110:111], v[156:157]
    v_pk_fma_f32 v[156:157], v[112:113], v[112:113], v[156:157]
    v_pk_fma_f32 v[156:157], v[114:115], v[114:115], v[156:157]
    v_lshlrev_b32 v116, 16, v92
    v_and_b32 v117, 0xffff0000, v92
    v_lshlrev_b32 v118, 16, v93
    v_and_b32 v119, 0xffff0000, v93
    v_lshlrev_b32 v120, 16, v94
    v_and_b32 v121, 0xffff0000, v94
    v_lshlrev_b32 v122, 16, v95
    v_and_b32 v123, 0xffff0000, v95
    v_pk_add_f32 v[116:117], v[116:117], v[154:155] op_sel_hi:[1,0]
    v_pk_add_f32 v[118:119], v[118:119], v[154:155] op_sel_hi:[1,0]
    v_pk_add_f32 v[120:121], v[120:121], v[154:155] op_sel_hi:[1,0]
    v_pk_add_f32 v[122:123], v[122:123], v[154:155] op_sel_hi:[1,0]
    v_pk_fma_f32 v[116:117], v[68:69], v[150:151], v[116:117] op_sel_hi:[1,0,1]
    v_pk_fma_f32 v[118:119], v[70:71], v[150:151], v[118:119] op_sel_hi:[1,0,1]
    v_pk_fma_f32 v[120:121], v[72:73], v[150:151], v[120:121] op_sel_hi:[1,0,1]
    v_pk_fma_f32 v[122:123], v[74:75], v[150:151], v[122:123] op_sel_hi:[1,0,1]
    v_cvt_pk_bf16_f32 v140, v116, v117
    v_cvt_pk_bf16_f32 v141, v118, v119
    v_cvt_pk_bf16_f32 v142, v120, v121
    v_cvt_pk_bf16_f32 v143, v122, v123
    s_add_u32 s25, s24, 40960
    buffer_store_dwordx4 v[140:143], v12, s[12:15], s25 offen sc1
    v_pk_mul_f32 v[158:159], v[116:117], v[116:117]
    v_pk_fma_f32 v[158:159], v[118:119], v[118:119], v[158:159]
    v_pk_fma_f32 v[158:159], v[120:121], v[120:121], v[158:159]
    v_pk_fma_f32 v[158:159], v[122:123], v[122:123], v[158:159]
    v_lshlrev_b32 v124, 16, v96
    v_and_b32 v125, 0xffff0000, v96
    v_lshlrev_b32 v126, 16, v97
    v_and_b32 v127, 0xffff0000, v97
    v_lshlrev_b32 v128, 16, v98
    v_and_b32 v129, 0xffff0000, v98
    v_lshlrev_b32 v130, 16, v99
    v_and_b32 v131, 0xffff0000, v99
    v_pk_add_f32 v[124:125], v[124:125], v[154:155] op_sel_hi:[1,0]
    v_pk_add_f32 v[126:127], v[126:127], v[154:155] op_sel_hi:[1,0]
    v_pk_add_f32 v[128:129], v[128:129], v[154:155] op_sel_hi:[1,0]
    v_pk_add_f32 v[130:131], v[130:131], v[154:155] op_sel_hi:[1,0]
    v_pk_fma_f32 v[124:125], v[76:77], v[150:151], v[124:125] op_sel_hi:[1,0,1]
    v_pk_fma_f32 v[126:127], v[78:79], v[150:151], v[126:127] op_sel_hi:[1,0,1]
    v_pk_fma_f32 v[128:129], v[80:81], v[150:151], v[128:129] op_sel_hi:[1,0,1]
    v_pk_fma_f32 v[130:131], v[82:83], v[150:151], v[130:131] op_sel_hi:[1,0,1]
    v_cvt_pk_bf16_f32 v144, v124, v125
    v_cvt_pk_bf16_f32 v145, v126, v127
    v_cvt_pk_bf16_f32 v146, v128, v129
    v_cvt_pk_bf16_f32 v147, v130, v131
    s_add_u32 s25, s24, 41984
    buffer_store_dwordx4 v[144:147], v12, s[12:15], s25 offen sc1
    v_pk_fma_f32 v[158:159], v[124:125], v[124:125], v[158:159]
    v_pk_fma_f32 v[158:159], v[126:127], v[126:127], v[158:159]
    v_pk_fma_f32 v[158:159], v[128:129], v[128:129], v[158:159]
    v_pk_fma_f32 v[158:159], v[130:131], v[130:131], v[158:159]
    v_add_f32 v156, v156, v157
    v_add_f32 v158, v158, v159
    s_mul_i32 s24, s17, 5120
    s_lshl_b32 s25, s26, 8
    s_add_u32 s24, s24, s25
    s_add_u32 s24, s24, 17301504
    v_permlane32_swap_b32 v156, v158
    v_lshlrev_b32 v3, 2, v1
    s_nop 0
    v_add_f32 v156, v156, v158
    buffer_store_dword v156, v3, s[12:15], s24 offen sc1
    s_mul_i32 s24, s17, 20
    s_add_u32 s24, s24, s26
    s_lshl_b32 s24, s24, 7
    s_add_u32 s24, s24, 24248320
    v_mov_b32 v3, s78
    s_mov_b64 exec, 1
    s_waitcnt vmcnt(0)
    buffer_store_dword v3, off, s[12:15], s24 sc1
    s_mov_b64 exec, -1
    s_branch k345_p4
k345_p3_prod:
    v_lshrrev_b32 v2, 4, v1
    v_lshlrev_b32 v3, 2, v2
    v_xor_b32 v3, v3, v1
    v_and_b32 v3, 15, v3
    v_lshrrev_b32 v4, 3, v3
    v_and_b32 v3, 7, v3
    v_lshlrev_b32 v3, 4, v3
    v_lshl_add_u32 v3, v4, 12, v3
    v_lshl_add_u32 v5, v2, 13, v3
    s_lshl_b32 s19, s17, 7
    s_lshl_b32 s20, s16, 16
    s_add_u32 s19, s19, s20
    s_add_u32 s19, s19, 5242880
    s_lshl_b32 s20, s16, 11
    s_waitcnt lgkmcnt(0)
    s_mov_b32 s12, s6
    s_mov_b32 s13, s7
    s_mov_b32 s14, 24772608
    s_mov_b32 s15, 0x00020000
    s_mov_b32 s8, s4
    s_mov_b32 s9, s5
    s_mov_b32 s10, 2621440
    s_mov_b32 s11, 0x00020000
    v_lshrrev_b32 v2, 3, v1
    v_lshlrev_b32 v3, 5, v2
    v_and_b32 v4, 7, v1
    v_add_u32 v3, v3, v4
    v_and_b32 v2, 1, v2
    v_lshl_add_u32 v2, v2, 5, v4
    v_add_u32 v2, 256, v2
    s_lshr_b32 s22, s17, 3
    s_mul_i32 s22, s22, 320
    s_lshl_b32 s23, s16, 3
    s_add_u32 s22, s22, s23
    s_lshl_b32 s22, s22, 7
    s_add_u32 s22, s22, 24510464
    v_lshlrev_b32 v3, 7, v3
    v_lshlrev_b32 v2, 7, v2
    s_barrier
    s_mov_b32 s57, 20000
k1_kernel_poll17:
    buffer_load_dword v6, v3, s[12:15], s22 offen sc1
    buffer_load_dword v7, v2, s[12:15], s22 offen sc1
    s_sub_u32 s57, s57, 1
    s_cmp_eq_u32 s57, 0
    s_cbranch_scc1 k1_kernel_got18
    s_waitcnt vmcnt(0)
    v_cmp_ne_u32 vcc, s78, v6
    s_mov_b64 s[76:77], vcc
    v_cmp_ne_u32 vcc, s78, v7
    s_or_b64 vcc, vcc, s[76:77]
    s_cmp_lg_u64 vcc, 0
    s_cbranch_scc1 k1_kernel_poll17
k1_kernel_got18:
    s_waitcnt vmcnt(0)
    v_lshrrev_b32 v2, 4, v1
    s_add_u32 m0, s20, 0
    s_add_u32 s22, s19, 0
    buffer_load_dwordx4 v5, s[12:15], s22 offen lds
    s_add_u32 m0, s20, 1024
    s_add_u32 s22, s19, 32768
    buffer_load_dwordx4 v5, s[12:15], s22 offen lds
    s_add_u32 m0, s20, 8192
    s_add_u32 s22, s19, 262144
    buffer_load_dwordx4 v5, s[12:15], s22 offen lds
    s_add_u32 m0, s20, 9216
    s_add_u32 s22, s19, 294912
    buffer_load_dwordx4 v5, s[12:15], s22 offen lds
    s_add_u32 m0, s20, 16384
    s_add_u32 s22, s19, 524288
    buffer_load_dwordx4 v5, s[12:15], s22 offen lds
    s_add_u32 m0, s20, 17408
    s_add_u32 s22, s19, 557056
    buffer_load_dwordx4 v5, s[12:15], s22 offen lds
    s_add_u32 m0, s20, 24576
    s_add_u32 s22, s19, 786432
    buffer_load_dwordx4 v5, s[12:15], s22 offen lds
    s_add_u32 m0, s20, 25600
    s_add_u32 s22, s19, 819200
    buffer_load_dwordx4 v5, s[12:15], s22 offen lds
    s_add_u32 m0, s20, 32768
    s_add_u32 s22, s19, 1048576
    buffer_load_dwordx4 v5, s[12:15], s22 offen lds
    s_add_u32 m0, s20, 33792
    s_add_u32 s22, s19, 1081344
    buffer_load_dwordx4 v5, s[12:15], s22 offen lds
    s_add_u32 m0, s20, 40960
    s_add_u32 s22, s19, 1310720
    buffer_load_dwordx4 v5, s[12:15], s22 offen lds
    s_add_u32 m0, s20, 41984
    s_add_u32 s22, s19, 1343488
    buffer_load_dwordx4 v5, s[12:15], s22 offen lds
    s_add_u32 m0, s20, 49152
    s_add_u32 s22, s19, 1572864
    buffer_load_dwordx4 v5, s[12:15], s22 offen lds
    s_add_u32 m0, s20, 50176
    s_add_u32 s22, s19, 1605632
    buffer_load_dwordx4 v5, s[12:15], s22 offen lds
    s_add_u32 m0, s20, 57344
    s_add_u32 s22, s19, 1835008
    buffer_load_dwordx4 v5, s[12:15], s22 offen lds
    s_add_u32 m0, s20, 58368
    s_add_u32 s22, s19, 1867776
    buffer_load_dwordx4 v5, s[12:15], s22 offen lds
    s_add_u32 m0, s20, 65536
    s_add_u32 s22, s19, 2097152
    buffer_load_dwordx4 v5, s[12:15], s22 offen lds
    s_add_u32 m0, s20, 66560
    s_add_u32 s22, s19, 2129920
    buffer_load_dwordx4 v5, s[12:15], s22 offen lds
    s_add_u32 m0, s20, 73728
    s_add_u32 s22, s19, 2359296
    buffer_load_dwordx4 v5, s[12:15], s22 offen lds
    s_add_u32 m0, s20, 74752
    s_add_u32 s22, s19, 2392064
    buffer_load_dwordx4 v5, s[12:15], s22 offen lds
    v_xor_b32 v3, v2, v1
    v_and_b32 v3, 15, v3
    v_lshlrev_b32 v3, 4, v3
    v_mul_u32_u24 v4, 1280, v2
    v_xor_b32 v6, 0, v3
    v_add_u32 v6, v6, v4
    v_xor_b32 v7, 64, v3
    v_add_u32 v7, v7, v4
    v_xor_b32 v8, 128, v3
    v_add_u32 v8, v8, v4
    v_xor_b32 v9, 192, v3
    v_add_u32 v9, v9, v4
    s_lshl_b32 s22, s17, 2
    s_add_u32 s22, s22, s16
    s_mul_i32 s21, s22, 20480
    s_lshl_b32 s23, s18, 8
    s_add_u32 s21, s21, s23
    s_lshl_b32 s23, s16, 12
    s_add_u32 m0, s23, 81920
    s_add_u32 s22, s21, 0
    buffer_load_dwordx4 v6, s[8:11], s22 offen lds
    s_add_u32 m0, s23, 82944
    s_add_u32 s22, s21, 5120
    buffer_load_dwordx4 v7, s[8:11], s22 offen lds
    s_add_u32 m0, s23, 83968
    s_add_u32 s22, s21, 10240
    buffer_load_dwordx4 v8, s[8:11], s22 offen lds
    s_add_u32 m0, s23, 84992
    s_add_u32 s22, s21, 15360
    buffer_load_dwordx4 v9, s[8:11], s22 offen lds
    s_waitcnt vmcnt(20)
    s_barrier
    s_waitcnt vmcnt(16)
    s_barrier
    s_waitcnt vmcnt(12)
    s_barrier
    s_waitcnt vmcnt(8)
    s_barrier
    s_waitcnt vmcnt(4)
    s_barrier
    s_waitcnt vmcnt(0)
    s_barrier
    s_branch k345_p4
k345_p4:
    v_and_b32 v1, 63, v0
    v_lshrrev_b32 v2, 6, v0
    s_and_b32 s22, s2, 7
    s_lshr_b32 s23, s2, 3
    v_readfirstlane_b32 s21, v2
    s_and_b32 s16, s21, 3
    s_and_b32 s24, s22, 3
    s_lshl_b32 s24, s24, 2
    s_and_b32 s25, s23, 3
    s_add_u32 s20, s24, s25
    s_lshr_b32 s24, s22, 2
    s_lshl_b32 s24, s24, 3
    s_lshr_b32 s25, s23, 2
    s_add_u32 s19, s24, s25
    s_lshr_b32 s17, s16, 1
    s_and_b32 s18, s16, 1
    v_lshlrev_b32 v4, 4, v1
    s_mul_i32 s26, s20, 245760
    s_mul_i32 s22, s16, 3072
    s_add_u32 s26, s26, s22
    s_add_u32 s26, s26, 17825792
    s_lshl_b32 s23, s19, 2
    s_add_u32 s23, s23, s16
    s_mul_i32 s27, s23, 40960
    s_add_u32 s27, s27, 7864320
    s_mov_b32 s28, s22
    s_lshl_b32 s29, s16, 11
    s_add_u32 s29, s29, 12288
    s_lshl_b32 s23, s19, 1
    s_add_u32 s23, s23, s18
    s_mul_i32 s30, s23, 5120
    s_add_u32 s30, s30, 17301504
    v_lshlrev_b32 v3, 2, v1
    s_waitcnt lgkmcnt(0)
    s_mov_b32 s8, s6
    s_mov_b32 s9, s7
    s_mov_b32 s10, 24772608
    s_mov_b32 s11, 0x00020000
    s_mov_b32 s12, s58
    s_mov_b32 s13, s59
    s_mov_b32 s14, 2621440
    s_mov_b32 s15, 0x00020000
    s_and_b32 s22, s2, 7
    s_lshl_b32 s22, s22, 2
    s_lshr_b32 s23, s2, 6
    s_add_u32 s36, s22, s23
    s_lshr_b32 s23, s2, 3
    s_and_b32 s37, s23, 7
    s_mul_i32 s38, s21, 240
    s_mul_i32 s22, s37, 5
    s_add_u32 s38, s38, s22
    s_lshl_b32 s38, s38, 10
    s_add_u32 s38, s38, 22020096
    s_mov_b32 s34, 0
    s_cmp_ge_u32 s21, 4
    s_cbranch_scc1 k345_prod
    s_mul_i32 s23, s17, 3072
    v_add_u32 v5, s23, v4
    s_lshl_b32 s23, s18, 12
    s_add_u32 s23, s23, 12288
    v_add_u32 v8, s23, v4
    v_add_u32 v6, 61440, v5
    v_add_u32 v9, 61440, v8
    v_add_u32 v7, 122880, v5
    v_add_u32 v10, 122880, v8
    v_bfe_u32 v2, v1, 4, 1
    v_mul_u32_u24 v2, 49152, v2
    v_lshrrev_b32 v11, 5, v1
    v_lshl_add_u32 v2, v11, 8, v2
    v_and_b32 v11, 15, v1
    v_lshl_add_u32 v11, v11, 4, v2
    v_add_u32 v2, 4096, v4
    s_barrier
    buffer_load_dword v20, v3, s[8:11], s30 offen offset:0
    s_add_u32 s31, s30, 4096
    buffer_load_dword v21, v3, s[8:11], s30 offen offset:256
    buffer_load_dword v22, v3, s[8:11], s30 offen offset:512
    buffer_load_dword v23, v3, s[8:11], s30 offen offset:768
    buffer_load_dword v24, v3, s[8:11], s30 offen offset:1024
    buffer_load_dword v25, v3, s[8:11], s30 offen offset:1280
    buffer_load_dword v26, v3, s[8:11], s30 offen offset:1536
    buffer_load_dword v27, v3, s[8:11], s30 offen offset:1792
    buffer_load_dword v28, v3, s[8:11], s30 offen offset:2048
    buffer_load_dword v29, v3, s[8:11], s30 offen offset:2304
    buffer_load_dword v30, v3, s[8:11], s30 offen offset:2560
    buffer_load_dword v31, v3, s[8:11], s30 offen offset:2816
    buffer_load_dword v32, v3, s[8:11], s30 offen offset:3072
    buffer_load_dword v33, v3, s[8:11], s30 offen offset:3328
    buffer_load_dword v34, v3, s[8:11], s30 offen offset:3584
    buffer_load_dword v35, v3, s[8:11], s30 offen offset:3840
    buffer_load_dword v36, v3, s[8:11], s31 offen offset:0
    buffer_load_dword v37, v3, s[8:11], s31 offen offset:256
    buffer_load_dword v38, v3, s[8:11], s31 offen offset:512
    buffer_load_dword v39, v3, s[8:11], s31 offen offset:768
    ds_read_b128 v[136:139], v5 offset:0
    ds_read_b128 v[160:163], v8 offset:0
    ds_read_b128 v[164:167], v8 offset:2048
    ds_read_b128 v[140:143], v5 offset:1024
    ds_read_b128 v[144:147], v5 offset:2048
    s_waitcnt lgkmcnt(0)
    v_mfma_f32_32x32x16_bf16 v[40:55], v[136:139], v[160:163], 0
    ds_read_b128 v[148:151], v5 offset:6144
    ds_read_b128 v[168:171], v8 offset:1024
    v_mfma_f32_32x32x16_bf16 v[56:71], v[136:139], v[164:167], 0
    ds_read_b128 v[172:175], v8 offset:3072
    ds_read_b128 v[152:155], v5 offset:7168
    v_mfma_f32_32x32x16_bf16 v[72:87], v[140:143], v[160:163], 0
    ds_read_b128 v[156:159], v5 offset:8192
    v_mfma_f32_32x32x16_bf16 v[88:103], v[140:143], v[164:167], 0
    v_mfma_f32_32x32x16_bf16 v[104:119], v[144:147], v[160:163], 0
    v_mfma_f32_32x32x16_bf16 v[120:135], v[144:147], v[164:167], 0
    s_waitcnt lgkmcnt(0)
    s_barrier
    v_mfma_f32_32x32x16_bf16 v[40:55], v[148:151], v[168:171], v[40:55]
    ds_read_b128 v[136:139], v5 offset:20480
    ds_read_b128 v[160:163], v8 offset:20480
    v_mfma_f32_32x32x16_bf16 v[56:71], v[148:151], v[172:175], v[56:71]
    ds_read_b128 v[164:167], v8 offset:22528
    ds_read_b128 v[140:143], v5 offset:21504
    v_mfma_f32_32x32x16_bf16 v[72:87], v[152:155], v[168:171], v[72:87]
    ds_read_b128 v[144:147], v5 offset:22528
    v_mfma_f32_32x32x16_bf16 v[88:103], v[152:155], v[172:175], v[88:103]
    v_mfma_f32_32x32x16_bf16 v[104:119], v[156:159], v[168:171], v[104:119]
    v_mfma_f32_32x32x16_bf16 v[120:135], v[156:159], v[172:175], v[120:135]
    s_waitcnt lgkmcnt(0)
    v_mfma_f32_32x32x16_bf16 v[40:55], v[136:139], v[160:163], v[40:55]
    ds_read_b128 v[148:151], v5 offset:26624
    ds_read_b128 v[168:171], v8 offset:21504
    v_mfma_f32_32x32x16_bf16 v[56:71], v[136:139], v[164:167], v[56:71]
    ds_read_b128 v[172:175], v8 offset:23552
    ds_read_b128 v[152:155], v5 offset:27648
    v_mfma_f32_32x32x16_bf16 v[72:87], v[140:143], v[160:163], v[72:87]
    ds_read_b128 v[156:159], v5 offset:28672
    v_mfma_f32_32x32x16_bf16 v[88:103], v[140:143], v[164:167], v[88:103]
    v_mfma_f32_32x32x16_bf16 v[104:119], v[144:147], v[160:163], v[104:119]
    v_mfma_f32_32x32x16_bf16 v[120:135], v[144:147], v[164:167], v[120:135]
    s_waitcnt lgkmcnt(0)
    s_barrier
    v_mfma_f32_32x32x16_bf16 v[40:55], v[148:151], v[168:171], v[40:55]
    ds_read_b128 v[136:139], v5 offset:40960
    ds_read_b128 v[160:163], v8 offset:40960
    v_mfma_f32_32x32x16_bf16 v[56:71], v[148:151], v[172:175], v[56:71]
    ds_read_b128 v[164:167], v8 offset:43008
    ds_read_b128 v[140:143], v5 offset:41984
    v_mfma_f32_32x32x16_bf16 v[72:87], v[152:155], v[168:171], v[72:87]
    ds_read_b128 v[144:147], v5 offset:43008
    v_mfma_f32_32x32x16_bf16 v[88:103], v[152:155], v[172:175], v[88:103]
    v_mfma_f32_32x32x16_bf16 v[104:119], v[156:159], v[168:171], v[104:119]
    v_mfma_f32_32x32x16_bf16 v[120:135], v[156:159], v[172:175], v[120:135]
    s_waitcnt lgkmcnt(0)
    v_mfma_f32_32x32x16_bf16 v[40:55], v[136:139], v[160:163], v[40:55]
    ds_read_b128 v[148:151], v5 offset:47104
    ds_read_b128 v[168:171], v8 offset:41984
    v_mfma_f32_32x32x16_bf16 v[56:71], v[136:139], v[164:167], v[56:71]
    ds_read_b128 v[172:175], v8 offset:44032
    ds_read_b128 v[152:155], v5 offset:48128
    v_mfma_f32_32x32x16_bf16 v[72:87], v[140:143], v[160:163], v[72:87]
    ds_read_b128 v[156:159], v5 offset:49152
    v_mfma_f32_32x32x16_bf16 v[88:103], v[140:143], v[164:167], v[88:103]
    v_mfma_f32_32x32x16_bf16 v[104:119], v[144:147], v[160:163], v[104:119]
    v_mfma_f32_32x32x16_bf16 v[120:135], v[144:147], v[164:167], v[120:135]
    s_waitcnt lgkmcnt(0)
    s_barrier
    v_mfma_f32_32x32x16_bf16 v[40:55], v[148:151], v[168:171], v[40:55]
    ds_read_b128 v[136:139], v6 offset:0
    ds_read_b128 v[160:163], v9 offset:0
    v_mfma_f32_32x32x16_bf16 v[56:71], v[148:151], v[172:175], v[56:71]
    ds_read_b128 v[164:167], v9 offset:2048
    ds_read_b128 v[140:143], v6 offset:1024
    v_mfma_f32_32x32x16_bf16 v[72:87], v[152:155], v[168:171], v[72:87]
    ds_read_b128 v[144:147], v6 offset:2048
    v_mfma_f32_32x32x16_bf16 v[88:103], v[152:155], v[172:175], v[88:103]
    v_mfma_f32_32x32x16_bf16 v[104:119], v[156:159], v[168:171], v[104:119]
    v_mfma_f32_32x32x16_bf16 v[120:135], v[156:159], v[172:175], v[120:135]
    s_waitcnt lgkmcnt(0)
    v_mfma_f32_32x32x16_bf16 v[40:55], v[136:139], v[160:163], v[40:55]
    ds_read_b128 v[148:151], v6 offset:6144
    ds_read_b128 v[168:171], v9 offset:1024
    s_waitcnt vmcnt(0)
    v_add_f32 v20, v20, v21
    v_add_f32 v22, v22, v23
    v_mfma_f32_32x32x16_bf16 v[56:71], v[136:139], v[164:167], v[56:71]
    ds_read_b128 v[172:175], v9 offset:3072
    ds_read_b128 v[152:155], v6 offset:7168
    v_add_f32 v24, v24, v25
    v_add_f32 v26, v26, v27
    v_add_f32 v28, v28, v29
    v_mfma_f32_32x32x16_bf16 v[72:87], v[140:143], v[160:163], v[72:87]
    ds_read_b128 v[156:159], v6 offset:8192
    v_add_f32 v30, v30, v31
    v_add_f32 v32, v32, v33
    v_add_f32 v34, v34, v35
    v_mfma_f32_32x32x16_bf16 v[88:103], v[140:143], v[164:167], v[88:103]
    v_add_f32 v36, v36, v37
    v_add_f32 v38, v38, v39
    v_add_f32 v20, v20, v22
    v_mfma_f32_32x32x16_bf16 v[104:119], v[144:147], v[160:163], v[104:119]
    v_add_f32 v24, v24, v26
    v_add_f32 v28, v28, v30
    v_add_f32 v32, v32, v34
    v_mfma_f32_32x32x16_bf16 v[120:135], v[144:147], v[164:167], v[120:135]
    v_add_f32 v36, v36, v38
    v_add_f32 v20, v20, v24
    v_add_f32 v28, v28, v32
    s_waitcnt lgkmcnt(0)
    s_barrier
    v_mfma_f32_32x32x16_bf16 v[40:55], v[148:151], v[168:171], v[40:55]
    ds_read_b128 v[136:139], v6 offset:20480
    ds_read_b128 v[160:163], v9 offset:20480
    v_add_f32 v20, v20, v36
    v_add_f32 v20, v20, v28
    v_mul_f32 v20, 0x3acccccd, v20
    v_mfma_f32_32x32x16_bf16 v[56:71], v[148:151], v[172:175], v[56:71]
    ds_read_b128 v[164:167], v9 offset:22528
    ds_read_b128 v[140:143], v6 offset:21504
    v_add_f32 v20, 0x3727c5ac, v20
    v_mov_b32 v21, v20
    s_nop 1
    v_mfma_f32_32x32x16_bf16 v[72:87], v[152:155], v[168:171], v[72:87]
    ds_read_b128 v[144:147], v6 offset:22528
    v_permlane32_swap_b32 v20, v21
    s_nop 1
    v_rsq_f32 v22, v20
    v_mfma_f32_32x32x16_bf16 v[88:103], v[152:155], v[172:175], v[88:103]
    v_rsq_f32 v23, v21
    s_nop 0
    v_mul_f32 v12, 0xbfb8aa3b, v22
    v_mfma_f32_32x32x16_bf16 v[104:119], v[156:159], v[168:171], v[104:119]
    v_mul_f32 v16, 0xbfb8aa3b, v23
    v_mov_b32 v14, v20
    v_mov_b32 v18, v21
    v_mfma_f32_32x32x16_bf16 v[120:135], v[156:159], v[172:175], v[120:135]
    s_waitcnt lgkmcnt(0)
    v_mfma_f32_32x32x16_bf16 v[40:55], v[136:139], v[160:163], v[40:55]
    ds_read_b128 v[148:151], v6 offset:26624
    ds_read_b128 v[168:171], v9 offset:21504
    v_mfma_f32_32x32x16_bf16 v[56:71], v[136:139], v[164:167], v[56:71]
    ds_read_b128 v[172:175], v9 offset:23552
    ds_read_b128 v[152:155], v6 offset:27648
    v_mfma_f32_32x32x16_bf16 v[72:87], v[140:143], v[160:163], v[72:87]
    ds_read_b128 v[156:159], v6 offset:28672
    v_mfma_f32_32x32x16_bf16 v[88:103], v[140:143], v[164:167], v[88:103]
    v_mfma_f32_32x32x16_bf16 v[104:119], v[144:147], v[160:163], v[104:119]
    v_mfma_f32_32x32x16_bf16 v[120:135], v[144:147], v[164:167], v[120:135]
    s_waitcnt lgkmcnt(0)
    s_barrier
    v_mfma_f32_32x32x16_bf16 v[40:55], v[148:151], v[168:171], v[40:55]
    ds_read_b128 v[136:139], v6 offset:40960
    ds_read_b128 v[160:163], v9 offset:40960
    v_mfma_f32_32x32x16_bf16 v[56:71], v[148:151], v[172:175], v[56:71]
    ds_read_b128 v[164:167], v9 offset:43008
    ds_read_b128 v[140:143], v6 offset:41984
    v_mfma_f32_32x32x16_bf16 v[72:87], v[152:155], v[168:171], v[72:87]
    ds_read_b128 v[144:147], v6 offset:43008
    v_mfma_f32_32x32x16_bf16 v[88:103], v[152:155], v[172:175], v[88:103]
    v_mfma_f32_32x32x16_bf16 v[104:119], v[156:159], v[168:171], v[104:119]
    v_mfma_f32_32x32x16_bf16 v[120:135], v[156:159], v[172:175], v[120:135]
    s_waitcnt lgkmcnt(0)
    v_mfma_f32_32x32x16_bf16 v[40:55], v[136:139], v[160:163], v[40:55]
    ds_read_b128 v[148:151], v6 offset:47104
    ds_read_b128 v[168:171], v9 offset:41984
    v_mfma_f32_32x32x16_bf16 v[56:71], v[136:139], v[164:167], v[56:71]
    ds_read_b128 v[172:175], v9 offset:44032
    ds_read_b128 v[152:155], v6 offset:48128
    v_mfma_f32_32x32x16_bf16 v[72:87], v[140:143], v[160:163], v[72:87]
    ds_read_b128 v[156:159], v6 offset:49152
    v_mfma_f32_32x32x16_bf16 v[88:103], v[140:143], v[164:167], v[88:103]
    v_mfma_f32_32x32x16_bf16 v[104:119], v[144:147], v[160:163], v[104:119]
    v_mfma_f32_32x32x16_bf16 v[120:135], v[144:147], v[164:167], v[120:135]
    s_waitcnt lgkmcnt(0)
    s_barrier
    v_mfma_f32_32x32x16_bf16 v[40:55], v[148:151], v[168:171], v[40:55]
    ds_read_b128 v[136:139], v7 offset:0
    ds_read_b128 v[160:163], v10 offset:0
    v_mfma_f32_32x32x16_bf16 v[56:71], v[148:151], v[172:175], v[56:71]
    ds_read_b128 v[164:167], v10 offset:2048
    ds_read_b128 v[140:143], v7 offset:1024
    v_mfma_f32_32x32x16_bf16 v[72:87], v[152:155], v[168:171], v[72:87]
    ds_read_b128 v[144:147], v7 offset:2048
    v_mfma_f32_32x32x16_bf16 v[88:103], v[152:155], v[172:175], v[88:103]
    v_mfma_f32_32x32x16_bf16 v[104:119], v[156:159], v[168:171], v[104:119]
    v_mfma_f32_32x32x16_bf16 v[120:135], v[156:159], v[172:175], v[120:135]
    s_waitcnt lgkmcnt(0)
    v_mfma_f32_32x32x16_bf16 v[40:55], v[136:139], v[160:163], v[40:55]
    ds_read_b128 v[148:151], v7 offset:6144
    ds_read_b128 v[168:171], v10 offset:1024
    v_mfma_f32_32x32x16_bf16 v[56:71], v[136:139], v[164:167], v[56:71]
    ds_read_b128 v[172:175], v10 offset:3072
    ds_read_b128 v[152:155], v7 offset:7168
    v_mfma_f32_32x32x16_bf16 v[72:87], v[140:143], v[160:163], v[72:87]
    ds_read_b128 v[156:159], v7 offset:8192
    v_mfma_f32_32x32x16_bf16 v[88:103], v[140:143], v[164:167], v[88:103]
    v_mfma_f32_32x32x16_bf16 v[104:119], v[144:147], v[160:163], v[104:119]
    v_mfma_f32_32x32x16_bf16 v[120:135], v[144:147], v[164:167], v[120:135]
    s_waitcnt lgkmcnt(0)
    s_barrier
    v_mfma_f32_32x32x16_bf16 v[40:55], v[148:151], v[168:171], v[40:55]
    ds_read_b128 v[136:139], v5 offset:0
    ds_read_b128 v[160:163], v8 offset:0
    v_mfma_f32_32x32x16_bf16 v[56:71], v[148:151], v[172:175], v[56:71]
    ds_read_b128 v[164:167], v8 offset:2048
    ds_read_b128 v[140:143], v5 offset:1024
    v_mfma_f32_32x32x16_bf16 v[72:87], v[152:155], v[168:171], v[72:87]
    ds_read_b128 v[144:147], v5 offset:2048
    v_mfma_f32_32x32x16_bf16 v[88:103], v[152:155], v[172:175], v[88:103]
    v_mfma_f32_32x32x16_bf16 v[104:119], v[156:159], v[168:171], v[104:119]
    v_mfma_f32_32x32x16_bf16 v[120:135], v[156:159], v[172:175], v[120:135]
    s_waitcnt lgkmcnt(0)
    v_mfma_f32_32x32x16_bf16 v[40:55], v[136:139], v[160:163], v[40:55]
    ds_read_b128 v[148:151], v5 offset:6144
    ds_read_b128 v[168:171], v8 offset:1024
    v_mfma_f32_32x32x16_bf16 v[56:71], v[136:139], v[164:167], v[56:71]
    ds_read_b128 v[172:175], v8 offset:3072
    ds_read_b128 v[152:155], v5 offset:7168
    v_mfma_f32_32x32x16_bf16 v[72:87], v[140:143], v[160:163], v[72:87]
    ds_read_b128 v[156:159], v5 offset:8192
    v_mfma_f32_32x32x16_bf16 v[88:103], v[140:143], v[164:167], v[88:103]
    v_mfma_f32_32x32x16_bf16 v[104:119], v[144:147], v[160:163], v[104:119]
    v_mfma_f32_32x32x16_bf16 v[120:135], v[144:147], v[164:167], v[120:135]
    s_waitcnt lgkmcnt(0)
    s_barrier
    v_mfma_f32_32x32x16_bf16 v[40:55], v[148:151], v[168:171], v[40:55]
    ds_read_b128 v[136:139], v5 offset:20480
    ds_read_b128 v[160:163], v8 offset:20480
    v_mfma_f32_32x32x16_bf16 v[56:71], v[148:151], v[172:175], v[56:71]
    ds_read_b128 v[164:167], v8 offset:22528
    ds_read_b128 v[140:143], v5 offset:21504
    v_mfma_f32_32x32x16_bf16 v[72:87], v[152:155], v[168:171], v[72:87]
    ds_read_b128 v[144:147], v5 offset:22528
    v_mfma_f32_32x32x16_bf16 v[88:103], v[152:155], v[172:175], v[88:103]
    v_mfma_f32_32x32x16_bf16 v[104:119], v[156:159], v[168:171], v[104:119]
    v_mfma_f32_32x32x16_bf16 v[120:135], v[156:159], v[172:175], v[120:135]
    s_waitcnt lgkmcnt(0)
    v_mfma_f32_32x32x16_bf16 v[40:55], v[136:139], v[160:163], v[40:55]
    ds_read_b128 v[148:151], v5 offset:26624
    ds_read_b128 v[168:171], v8 offset:21504
    v_mfma_f32_32x32x16_bf16 v[56:71], v[136:139], v[164:167], v[56:71]
    ds_read_b128 v[172:175], v8 offset:23552
    ds_read_b128 v[152:155], v5 offset:27648
    v_mfma_f32_32x32x16_bf16 v[72:87], v[140:143], v[160:163], v[72:87]
    ds_read_b128 v[156:159], v5 offset:28672
    v_mfma_f32_32x32x16_bf16 v[88:103], v[140:143], v[164:167], v[88:103]
    v_mfma_f32_32x32x16_bf16 v[104:119], v[144:147], v[160:163], v[104:119]
    v_mfma_f32_32x32x16_bf16 v[120:135], v[144:147], v[164:167], v[120:135]
    s_waitcnt lgkmcnt(0)
    s_barrier
    v_mfma_f32_32x32x16_bf16 v[40:55], v[148:151], v[168:171], v[40:55]
    ds_read_b128 v[136:139], v5 offset:40960
    ds_read_b128 v[160:163], v8 offset:40960
    v_mfma_f32_32x32x16_bf16 v[56:71], v[148:151], v[172:175], v[56:71]
    ds_read_b128 v[164:167], v8 offset:43008
    ds_read_b128 v[140:143], v5 offset:41984
    v_mfma_f32_32x32x16_bf16 v[72:87], v[152:155], v[168:171], v[72:87]
    ds_read_b128 v[144:147], v5 offset:43008
    v_mfma_f32_32x32x16_bf16 v[88:103], v[152:155], v[172:175], v[88:103]
    v_mfma_f32_32x32x16_bf16 v[104:119], v[156:159], v[168:171], v[104:119]
    v_mfma_f32_32x32x16_bf16 v[120:135], v[156:159], v[172:175], v[120:135]
    s_waitcnt lgkmcnt(0)
    v_mfma_f32_32x32x16_bf16 v[40:55], v[136:139], v[160:163], v[40:55]
    ds_read_b128 v[148:151], v5 offset:47104
    ds_read_b128 v[168:171], v8 offset:41984
    v_mfma_f32_32x32x16_bf16 v[56:71], v[136:139], v[164:167], v[56:71]
    ds_read_b128 v[172:175], v8 offset:44032
    ds_read_b128 v[152:155], v5 offset:48128
    v_mfma_f32_32x32x16_bf16 v[72:87], v[140:143], v[160:163], v[72:87]
    ds_read_b128 v[156:159], v5 offset:49152
    v_mfma_f32_32x32x16_bf16 v[88:103], v[140:143], v[164:167], v[88:103]
    v_mfma_f32_32x32x16_bf16 v[104:119], v[144:147], v[160:163], v[104:119]
    v_mfma_f32_32x32x16_bf16 v[120:135], v[144:147], v[164:167], v[120:135]
    s_waitcnt lgkmcnt(0)
    s_barrier
    v_mfma_f32_32x32x16_bf16 v[40:55], v[148:151], v[168:171], v[40:55]
    ds_read_b128 v[136:139], v6 offset:0
    ds_read_b128 v[160:163], v9 offset:0
    v_mfma_f32_32x32x16_bf16 v[56:71], v[148:151], v[172:175], v[56:71]
    ds_read_b128 v[164:167], v9 offset:2048
    ds_read_b128 v[140:143], v6 offset:1024
    v_mfma_f32_32x32x16_bf16 v[72:87], v[152:155], v[168:171], v[72:87]
    ds_read_b128 v[144:147], v6 offset:2048
    v_mfma_f32_32x32x16_bf16 v[88:103], v[152:155], v[172:175], v[88:103]
    v_mfma_f32_32x32x16_bf16 v[104:119], v[156:159], v[168:171], v[104:119]
    v_mfma_f32_32x32x16_bf16 v[120:135], v[156:159], v[172:175], v[120:135]
    s_waitcnt lgkmcnt(0)
    v_mfma_f32_32x32x16_bf16 v[40:55], v[136:139], v[160:163], v[40:55]
    ds_read_b128 v[148:151], v6 offset:6144
    ds_read_b128 v[168:171], v9 offset:1024
    v_mfma_f32_32x32x16_bf16 v[56:71], v[136:139], v[164:167], v[56:71]
    ds_read_b128 v[172:175], v9 offset:3072
    ds_read_b128 v[152:155], v6 offset:7168
    v_mfma_f32_32x32x16_bf16 v[72:87], v[140:143], v[160:163], v[72:87]
    ds_read_b128 v[156:159], v6 offset:8192
    v_mfma_f32_32x32x16_bf16 v[88:103], v[140:143], v[164:167], v[88:103]
    v_mfma_f32_32x32x16_bf16 v[104:119], v[144:147], v[160:163], v[104:119]
    v_mfma_f32_32x32x16_bf16 v[120:135], v[144:147], v[164:167], v[120:135]
    s_waitcnt lgkmcnt(0)
    s_barrier
    v_mfma_f32_32x32x16_bf16 v[40:55], v[148:151], v[168:171], v[40:55]
    ds_read_b128 v[136:139], v6 offset:20480
    ds_read_b128 v[160:163], v9 offset:20480
    v_mfma_f32_32x32x16_bf16 v[56:71], v[148:151], v[172:175], v[56:71]
    ds_read_b128 v[164:167], v9 offset:22528
    ds_read_b128 v[140:143], v6 offset:21504
    v_mfma_f32_32x32x16_bf16 v[72:87], v[152:155], v[168:171], v[72:87]
    ds_read_b128 v[144:147], v6 offset:22528
    v_mfma_f32_32x32x16_bf16 v[88:103], v[152:155], v[172:175], v[88:103]
    v_mfma_f32_32x32x16_bf16 v[104:119], v[156:159], v[168:171], v[104:119]
    v_mfma_f32_32x32x16_bf16 v[120:135], v[156:159], v[172:175], v[120:135]
    s_waitcnt lgkmcnt(0)
    v_mfma_f32_32x32x16_bf16 v[40:55], v[136:139], v[160:163], v[40:55]
    ds_read_b128 v[148:151], v6 offset:26624
    ds_read_b128 v[168:171], v9 offset:21504
    v_mfma_f32_32x32x16_bf16 v[56:71], v[136:139], v[164:167], v[56:71]
    ds_read_b128 v[172:175], v9 offset:23552
    ds_read_b128 v[152:155], v6 offset:27648
    v_mfma_f32_32x32x16_bf16 v[72:87], v[140:143], v[160:163], v[72:87]
    ds_read_b128 v[156:159], v6 offset:28672
    v_mfma_f32_32x32x16_bf16 v[88:103], v[140:143], v[164:167], v[88:103]
    v_mfma_f32_32x32x16_bf16 v[104:119], v[144:147], v[160:163], v[104:119]
    v_mfma_f32_32x32x16_bf16 v[120:135], v[144:147], v[164:167], v[120:135]
    s_waitcnt lgkmcnt(0)
    s_barrier
    v_mfma_f32_32x32x16_bf16 v[40:55], v[148:151], v[168:171], v[40:55]
    ds_read_b128 v[136:139], v6 offset:40960
    ds_read_b128 v[160:163], v9 offset:40960
    v_mfma_f32_32x32x16_bf16 v[56:71], v[148:151], v[172:175], v[56:71]
    ds_read_b128 v[164:167], v9 offset:43008
    ds_read_b128 v[140:143], v6 offset:41984
    v_mfma_f32_32x32x16_bf16 v[72:87], v[152:155], v[168:171], v[72:87]
    ds_read_b128 v[144:147], v6 offset:43008
    v_mfma_f32_32x32x16_bf16 v[88:103], v[152:155], v[172:175], v[88:103]
    v_mfma_f32_32x32x16_bf16 v[104:119], v[156:159], v[168:171], v[104:119]
    v_mfma_f32_32x32x16_bf16 v[120:135], v[156:159], v[172:175], v[120:135]
    s_waitcnt lgkmcnt(0)
    v_mfma_f32_32x32x16_bf16 v[40:55], v[136:139], v[160:163], v[40:55]
    ds_read_b128 v[148:151], v6 offset:47104
    ds_read_b128 v[168:171], v9 offset:41984
    v_mfma_f32_32x32x16_bf16 v[56:71], v[136:139], v[164:167], v[56:71]
    ds_read_b128 v[172:175], v9 offset:44032
    ds_read_b128 v[152:155], v6 offset:48128
    v_mfma_f32_32x32x16_bf16 v[72:87], v[140:143], v[160:163], v[72:87]
    ds_read_b128 v[156:159], v6 offset:49152
    v_mfma_f32_32x32x16_bf16 v[88:103], v[140:143], v[164:167], v[88:103]
    v_mfma_f32_32x32x16_bf16 v[104:119], v[144:147], v[160:163], v[104:119]
    v_mfma_f32_32x32x16_bf16 v[120:135], v[144:147], v[164:167], v[120:135]
    s_waitcnt lgkmcnt(0)
    s_barrier
    v_mfma_f32_32x32x16_bf16 v[40:55], v[148:151], v[168:171], v[40:55]
    ds_read_b128 v[136:139], v7 offset:0
    ds_read_b128 v[160:163], v10 offset:0
    v_mfma_f32_32x32x16_bf16 v[56:71], v[148:151], v[172:175], v[56:71]
    ds_read_b128 v[164:167], v10 offset:2048
    ds_read_b128 v[140:143], v7 offset:1024
    v_mfma_f32_32x32x16_bf16 v[72:87], v[152:155], v[168:171], v[72:87]
    ds_read_b128 v[144:147], v7 offset:2048
    v_mfma_f32_32x32x16_bf16 v[88:103], v[152:155], v[172:175], v[88:103]
    v_mfma_f32_32x32x16_bf16 v[104:119], v[156:159], v[168:171], v[104:119]
    v_mfma_f32_32x32x16_bf16 v[120:135], v[156:159], v[172:175], v[120:135]
    s_waitcnt lgkmcnt(0)
    v_mfma_f32_32x32x16_bf16 v[40:55], v[136:139], v[160:163], v[40:55]
    ds_read_b128 v[148:151], v7 offset:6144
    ds_read_b128 v[168:171], v10 offset:1024
    v_mfma_f32_32x32x16_bf16 v[56:71], v[136:139], v[164:167], v[56:71]
    ds_read_b128 v[172:175], v10 offset:3072
    ds_read_b128 v[152:155], v7 offset:7168
    v_mfma_f32_32x32x16_bf16 v[72:87], v[140:143], v[160:163], v[72:87]
    ds_read_b128 v[156:159], v7 offset:8192
    v_mfma_f32_32x32x16_bf16 v[88:103], v[140:143], v[164:167], v[88:103]
    s_add_u32 s35, s38, 81920
    buffer_load_dwordx4 v[176:179], v4, s[8:11], s35 offen offset:0
    v_mfma_f32_32x32x16_bf16 v[104:119], v[144:147], v[160:163], v[104:119]
    v_mfma_f32_32x32x16_bf16 v[120:135], v[144:147], v[164:167], v[120:135]
    buffer_load_dwordx4 v[180:183], v4, s[8:11], s35 offen offset:1024
    s_waitcnt lgkmcnt(0)
    s_barrier
    v_mfma_f32_32x32x16_bf16 v[40:55], v[148:151], v[168:171], v[40:55]
    ds_read_b128 v[136:139], v5 offset:0
    ds_read_b128 v[160:163], v8 offset:0
    v_mfma_f32_32x32x16_bf16 v[56:71], v[148:151], v[172:175], v[56:71]
    ds_read_b128 v[164:167], v8 offset:2048
    ds_read_b128 v[140:143], v5 offset:1024
    v_mfma_f32_32x32x16_bf16 v[72:87], v[152:155], v[168:171], v[72:87]
    ds_read_b128 v[144:147], v5 offset:2048
    v_mfma_f32_32x32x16_bf16 v[88:103], v[152:155], v[172:175], v[88:103]
    buffer_load_dwordx4 v[184:187], v4, s[8:11], s35 offen offset:2048
    v_mfma_f32_32x32x16_bf16 v[104:119], v[156:159], v[168:171], v[104:119]
    v_mfma_f32_32x32x16_bf16 v[120:135], v[156:159], v[172:175], v[120:135]
    buffer_load_dwordx4 v[188:191], v4, s[8:11], s35 offen offset:3072
    s_waitcnt lgkmcnt(0)
    v_mfma_f32_32x32x16_bf16 v[40:55], v[136:139], v[160:163], v[40:55]
    ds_read_b128 v[148:151], v5 offset:6144
    ds_read_b128 v[168:171], v8 offset:1024
    v_mfma_f32_32x32x16_bf16 v[56:71], v[136:139], v[164:167], v[56:71]
    ds_read_b128 v[172:175], v8 offset:3072
    ds_read_b128 v[152:155], v5 offset:7168
    v_mfma_f32_32x32x16_bf16 v[72:87], v[140:143], v[160:163], v[72:87]
    ds_read_b128 v[156:159], v5 offset:8192
    v_mfma_f32_32x32x16_bf16 v[88:103], v[140:143], v[164:167], v[88:103]
    buffer_load_dwordx4 v[192:195], v2, s[8:11], s35 offen offset:0
    v_mfma_f32_32x32x16_bf16 v[104:119], v[144:147], v[160:163], v[104:119]
    v_mfma_f32_32x32x16_bf16 v[120:135], v[144:147], v[164:167], v[120:135]
    s_add_u32 s35, s38, 122880
    buffer_load_dwordx4 v[196:199], v4, s[8:11], s35 offen offset:0
    s_waitcnt lgkmcnt(0)
    s_barrier
    v_mfma_f32_32x32x16_bf16 v[40:55], v[148:151], v[168:171], v[40:55]
    ds_read_b128 v[136:139], v5 offset:20480
    ds_read_b128 v[160:163], v8 offset:20480
    v_mfma_f32_32x32x16_bf16 v[56:71], v[148:151], v[172:175], v[56:71]
    ds_read_b128 v[164:167], v8 offset:22528
    ds_read_b128 v[140:143], v5 offset:21504
    v_mfma_f32_32x32x16_bf16 v[72:87], v[152:155], v[168:171], v[72:87]
    ds_read_b128 v[144:147], v5 offset:22528
    v_mfma_f32_32x32x16_bf16 v[88:103], v[152:155], v[172:175], v[88:103]
    buffer_load_dwordx4 v[200:203], v4, s[8:11], s35 offen offset:1024
    v_mfma_f32_32x32x16_bf16 v[104:119], v[156:159], v[168:171], v[104:119]
    v_mfma_f32_32x32x16_bf16 v[120:135], v[156:159], v[172:175], v[120:135]
    buffer_load_dwordx4 v[204:207], v4, s[8:11], s35 offen offset:2048
    s_waitcnt lgkmcnt(0)
    v_mfma_f32_32x32x16_bf16 v[40:55], v[136:139], v[160:163], v[40:55]
    ds_read_b128 v[148:151], v5 offset:26624
    ds_read_b128 v[168:171], v8 offset:21504
    v_mfma_f32_32x32x16_bf16 v[56:71], v[136:139], v[164:167], v[56:71]
    ds_read_b128 v[172:175], v8 offset:23552
    ds_read_b128 v[152:155], v5 offset:27648
    v_mfma_f32_32x32x16_bf16 v[72:87], v[140:143], v[160:163], v[72:87]
    ds_read_b128 v[156:159], v5 offset:28672
    v_mfma_f32_32x32x16_bf16 v[88:103], v[140:143], v[164:167], v[88:103]
    buffer_load_dwordx4 v[208:211], v4, s[8:11], s35 offen offset:3072
    v_mfma_f32_32x32x16_bf16 v[104:119], v[144:147], v[160:163], v[104:119]
    v_mfma_f32_32x32x16_bf16 v[120:135], v[144:147], v[164:167], v[120:135]
    buffer_load_dwordx4 v[212:215], v2, s[8:11], s35 offen offset:0
    s_waitcnt lgkmcnt(0)
    s_barrier
    v_mfma_f32_32x32x16_bf16 v[40:55], v[148:151], v[168:171], v[40:55]
    ds_read_b128 v[136:139], v5 offset:40960
    ds_read_b128 v[160:163], v8 offset:40960
    v_mfma_f32_32x32x16_bf16 v[56:71], v[148:151], v[172:175], v[56:71]
    ds_read_b128 v[164:167], v8 offset:43008
    ds_read_b128 v[140:143], v5 offset:41984
    v_mfma_f32_32x32x16_bf16 v[72:87], v[152:155], v[168:171], v[72:87]
    ds_read_b128 v[144:147], v5 offset:43008
    v_mfma_f32_32x32x16_bf16 v[88:103], v[152:155], v[172:175], v[88:103]
    s_add_u32 s35, s38, 163840
    buffer_load_dwordx4 v[216:219], v4, s[8:11], s35 offen offset:0
    v_mfma_f32_32x32x16_bf16 v[104:119], v[156:159], v[168:171], v[104:119]
    v_mfma_f32_32x32x16_bf16 v[120:135], v[156:159], v[172:175], v[120:135]
    buffer_load_dwordx4 v[220:223], v4, s[8:11], s35 offen offset:1024
    s_waitcnt lgkmcnt(0)
    v_mfma_f32_32x32x16_bf16 v[40:55], v[136:139], v[160:163], v[40:55]
    ds_read_b128 v[148:151], v5 offset:47104
    ds_read_b128 v[168:171], v8 offset:41984
    v_mfma_f32_32x32x16_bf16 v[56:71], v[136:139], v[164:167], v[56:71]
    ds_read_b128 v[172:175], v8 offset:44032
    ds_read_b128 v[152:155], v5 offset:48128
    v_mfma_f32_32x32x16_bf16 v[72:87], v[140:143], v[160:163], v[72:87]
    ds_read_b128 v[156:159], v5 offset:49152
    v_mfma_f32_32x32x16_bf16 v[88:103], v[140:143], v[164:167], v[88:103]
    buffer_load_dwordx4 v[224:227], v4, s[8:11], s35 offen offset:2048
    v_mfma_f32_32x32x16_bf16 v[104:119], v[144:147], v[160:163], v[104:119]
    v_mfma_f32_32x32x16_bf16 v[120:135], v[144:147], v[164:167], v[120:135]
    buffer_load_dwordx4 v[228:231], v4, s[8:11], s35 offen offset:3072
    s_waitcnt lgkmcnt(0)
    s_barrier
    v_mfma_f32_32x32x16_bf16 v[40:55], v[148:151], v[168:171], v[40:55]
    ds_read_b128 v[136:139], v6 offset:0
    ds_read_b128 v[160:163], v9 offset:0
    v_mfma_f32_32x32x16_bf16 v[56:71], v[148:151], v[172:175], v[56:71]
    ds_read_b128 v[164:167], v9 offset:2048
    ds_read_b128 v[140:143], v6 offset:1024
    v_mfma_f32_32x32x16_bf16 v[72:87], v[152:155], v[168:171], v[72:87]
    ds_read_b128 v[144:147], v6 offset:2048
    v_mfma_f32_32x32x16_bf16 v[88:103], v[152:155], v[172:175], v[88:103]
    buffer_load_dwordx4 v[232:235], v2, s[8:11], s35 offen offset:0
    v_mfma_f32_32x32x16_bf16 v[104:119], v[156:159], v[168:171], v[104:119]
    v_mfma_f32_32x32x16_bf16 v[120:135], v[156:159], v[172:175], v[120:135]
    s_add_u32 s35, s38, 204800
    buffer_load_dwordx4 v[236:239], v4, s[8:11], s35 offen offset:0
    s_waitcnt lgkmcnt(0)
    v_mfma_f32_32x32x16_bf16 v[40:55], v[136:139], v[160:163], v[40:55]
    ds_read_b128 v[148:151], v6 offset:6144
    ds_read_b128 v[168:171], v9 offset:1024
    v_mfma_f32_32x32x16_bf16 v[56:71], v[136:139], v[164:167], v[56:71]
    ds_read_b128 v[172:175], v9 offset:3072
    ds_read_b128 v[152:155], v6 offset:7168
    v_mfma_f32_32x32x16_bf16 v[72:87], v[140:143], v[160:163], v[72:87]
    ds_read_b128 v[156:159], v6 offset:8192
    v_mfma_f32_32x32x16_bf16 v[88:103], v[140:143], v[164:167], v[88:103]
    buffer_load_dwordx4 v[240:243], v4, s[8:11], s35 offen offset:1024
    v_mfma_f32_32x32x16_bf16 v[104:119], v[144:147], v[160:163], v[104:119]
    v_mfma_f32_32x32x16_bf16 v[120:135], v[144:147], v[164:167], v[120:135]
    buffer_load_dwordx4 v[244:247], v4, s[8:11], s35 offen offset:2048
    s_waitcnt lgkmcnt(0)
    s_barrier
    v_mfma_f32_32x32x16_bf16 v[40:55], v[148:151], v[168:171], v[40:55]
    ds_read_b128 v[136:139], v6 offset:20480
    ds_read_b128 v[160:163], v9 offset:20480
    v_mfma_f32_32x32x16_bf16 v[56:71], v[148:151], v[172:175], v[56:71]
    ds_read_b128 v[164:167], v9 offset:22528
    ds_read_b128 v[140:143], v6 offset:21504
    v_mfma_f32_32x32x16_bf16 v[72:87], v[152:155], v[168:171], v[72:87]
    ds_read_b128 v[144:147], v6 offset:22528
    v_mfma_f32_32x32x16_bf16 v[88:103], v[152:155], v[172:175], v[88:103]
    buffer_load_dwordx4 v[248:251], v4, s[8:11], s35 offen offset:3072
    v_mfma_f32_32x32x16_bf16 v[104:119], v[156:159], v[168:171], v[104:119]
    v_mfma_f32_32x32x16_bf16 v[120:135], v[156:159], v[172:175], v[120:135]
    buffer_load_dwordx4 v[252:255], v2, s[8:11], s35 offen offset:0
    s_waitcnt lgkmcnt(0)
    v_mfma_f32_32x32x16_bf16 v[40:55], v[136:139], v[160:163], v[40:55]
    ds_read_b128 v[148:151], v6 offset:26624
    ds_read_b128 v[168:171], v9 offset:21504
    v_mfma_f32_32x32x16_bf16 v[56:71], v[136:139], v[164:167], v[56:71]
    ds_read_b128 v[172:175], v9 offset:23552
    ds_read_b128 v[152:155], v6 offset:27648
    v_mfma_f32_32x32x16_bf16 v[72:87], v[140:143], v[160:163], v[72:87]
    ds_read_b128 v[156:159], v6 offset:28672
    v_mfma_f32_32x32x16_bf16 v[88:103], v[140:143], v[164:167], v[88:103]
    v_mfma_f32_32x32x16_bf16 v[104:119], v[144:147], v[160:163], v[104:119]
    v_mfma_f32_32x32x16_bf16 v[120:135], v[144:147], v[164:167], v[120:135]
    s_waitcnt lgkmcnt(0)
    s_barrier
    v_mfma_f32_32x32x16_bf16 v[40:55], v[148:151], v[168:171], v[40:55]
    ds_read_b128 v[136:139], v6 offset:40960
    ds_read_b128 v[160:163], v9 offset:40960
    v_mfma_f32_32x32x16_bf16 v[56:71], v[148:151], v[172:175], v[56:71]
    ds_read_b128 v[164:167], v9 offset:43008
    ds_read_b128 v[140:143], v6 offset:41984
    v_mfma_f32_32x32x16_bf16 v[72:87], v[152:155], v[168:171], v[72:87]
    ds_read_b128 v[144:147], v6 offset:43008
    v_mfma_f32_32x32x16_bf16 v[88:103], v[152:155], v[172:175], v[88:103]
    v_mfma_f32_32x32x16_bf16 v[104:119], v[156:159], v[168:171], v[104:119]
    v_mfma_f32_32x32x16_bf16 v[120:135], v[156:159], v[172:175], v[120:135]
    s_waitcnt lgkmcnt(0)
    v_mfma_f32_32x32x16_bf16 v[40:55], v[136:139], v[160:163], v[40:55]
    ds_read_b128 v[148:151], v6 offset:47104
    ds_read_b128 v[168:171], v9 offset:41984
    v_mfma_f32_32x32x16_bf16 v[56:71], v[136:139], v[164:167], v[56:71]
    ds_read_b128 v[172:175], v9 offset:44032
    ds_read_b128 v[152:155], v6 offset:48128
    v_mfma_f32_32x32x16_bf16 v[72:87], v[140:143], v[160:163], v[72:87]
    ds_read_b128 v[156:159], v6 offset:49152
    v_mfma_f32_32x32x16_bf16 v[88:103], v[140:143], v[164:167], v[88:103]
    v_mfma_f32_32x32x16_bf16 v[104:119], v[144:147], v[160:163], v[104:119]
    v_mfma_f32_32x32x16_bf16 v[120:135], v[144:147], v[164:167], v[120:135]
    s_waitcnt lgkmcnt(0)
    v_mfma_f32_32x32x16_bf16 v[40:55], v[148:151], v[168:171], v[40:55]
    v_mfma_f32_32x32x16_bf16 v[56:71], v[148:151], v[172:175], v[56:71]
    v_mfma_f32_32x32x16_bf16 v[72:87], v[152:155], v[168:171], v[72:87]
    v_mfma_f32_32x32x16_bf16 v[88:103], v[152:155], v[172:175], v[88:103]
    v_mfma_f32_32x32x16_bf16 v[104:119], v[156:159], v[168:171], v[104:119]
    v_mfma_f32_32x32x16_bf16 v[120:135], v[156:159], v[172:175], v[120:135]
    s_barrier
    s_lshl_b32 s23, s19, 2
    s_lshl_b32 s24, s18, 1
    s_add_u32 s23, s23, s24
    s_mul_i32 s23, s23, 98304
    s_add_u32 s23, s23, 10485760
    s_mul_i32 s24, s20, 6
    s_mul_i32 s25, s17, 3
    s_add_u32 s24, s24, s25
    s_lshl_b32 s24, s24, 9
    s_add_u32 s23, s23, s24
    s_nop 3
    s_add_u32 s35, s38, 0
    buffer_load_dwordx4 v[136:139], v4, s[8:11], s35 offen offset:0
    buffer_load_dwordx4 v[140:143], v4, s[8:11], s35 offen offset:1024
    v_pk_mul_f32 v[20:21], v[40:41], v[12:13] op_sel_hi:[1,0]
    v_pk_mul_f32 v[22:23], v[42:43], v[12:13] op_sel_hi:[1,0]
    v_pk_mul_f32 v[24:25], v[44:45], v[12:13] op_sel_hi:[1,0]
    v_pk_mul_f32 v[26:27], v[46:47], v[12:13] op_sel_hi:[1,0]
    v_exp_f32 v20, v20
    v_exp_f32 v21, v21
    v_exp_f32 v22, v22
    v_exp_f32 v23, v23
    v_exp_f32 v24, v24
    v_exp_f32 v25, v25
    v_exp_f32 v26, v26
    v_exp_f32 v27, v27
    buffer_load_dwordx4 v[144:147], v4, s[8:11], s35 offen offset:2048
    v_pk_mul_f32 v[28:29], v[56:57], v[16:17] op_sel_hi:[1,0]
    v_pk_mul_f32 v[30:31], v[58:59], v[16:17] op_sel_hi:[1,0]
    v_pk_mul_f32 v[32:33], v[60:61], v[16:17] op_sel_hi:[1,0]
    v_pk_mul_f32 v[34:35], v[62:63], v[16:17] op_sel_hi:[1,0]
    v_exp_f32 v28, v28
    v_exp_f32 v29, v29
    v_exp_f32 v30, v30
    v_exp_f32 v31, v31
    v_exp_f32 v32, v32
    v_exp_f32 v33, v33
    v_exp_f32 v34, v34
    v_exp_f32 v35, v35
    buffer_load_dwordx4 v[148:151], v4, s[8:11], s35 offen offset:3072
    v_pk_fma_f32 v[20:21], v[20:21], v[14:15], v[14:15] op_sel_hi:[1,0,0]
    v_pk_fma_f32 v[22:23], v[22:23], v[14:15], v[14:15] op_sel_hi:[1,0,0]
    v_pk_fma_f32 v[24:25], v[24:25], v[14:15], v[14:15] op_sel_hi:[1,0,0]
    v_pk_fma_f32 v[26:27], v[26:27], v[14:15], v[14:15] op_sel_hi:[1,0,0]
    v_pk_mul_f32 v[40:41], v[40:41], v[48:49]
    v_pk_mul_f32 v[42:43], v[42:43], v[50:51]
    v_pk_mul_f32 v[44:45], v[44:45], v[52:53]
    v_pk_mul_f32 v[46:47], v[46:47], v[54:55]
    v_rcp_f32 v20, v20
    v_rcp_f32 v21, v21
    v_rcp_f32 v22, v22
    v_rcp_f32 v23, v23
    v_rcp_f32 v24, v24
    v_rcp_f32 v25, v25
    v_rcp_f32 v26, v26
    v_rcp_f32 v27, v27
    s_nop 0
    v_pk_mul_f32 v[40:41], v[40:41], v[20:21]
    v_pk_mul_f32 v[42:43], v[42:43], v[22:23]
    v_pk_mul_f32 v[44:45], v[44:45], v[24:25]
    v_pk_mul_f32 v[46:47], v[46:47], v[26:27]
    v_cvt_pk_bf16_f32 v48, v40, v41
    v_cvt_pk_bf16_f32 v49, v42, v43
    v_cvt_pk_bf16_f32 v50, v44, v45
    v_cvt_pk_bf16_f32 v51, v46, v47
    s_add_u32 s25, s23, 0
    buffer_store_dwordx4 v[48:51], v11, s[8:11], s25 offen sc1
    buffer_load_dwordx4 v[152:155], v2, s[8:11], s35 offen offset:0
    v_pk_mul_f32 v[20:21], v[72:73], v[12:13] op_sel_hi:[1,0]
    v_pk_mul_f32 v[22:23], v[74:75], v[12:13] op_sel_hi:[1,0]
    v_pk_mul_f32 v[24:25], v[76:77], v[12:13] op_sel_hi:[1,0]
    v_pk_mul_f32 v[26:27], v[78:79], v[12:13] op_sel_hi:[1,0]
    v_exp_f32 v20, v20
    v_exp_f32 v21, v21
    v_exp_f32 v22, v22
    v_exp_f32 v23, v23
    v_exp_f32 v24, v24
    v_exp_f32 v25, v25
    v_exp_f32 v26, v26
    v_exp_f32 v27, v27
    s_add_u32 s35, s38, 40960
    buffer_load_dwordx4 v[156:159], v4, s[8:11], s35 offen offset:0
    v_pk_fma_f32 v[28:29], v[28:29], v[18:19], v[18:19] op_sel_hi:[1,0,0]
    v_pk_fma_f32 v[30:31], v[30:31], v[18:19], v[18:19] op_sel_hi:[1,0,0]
    v_pk_fma_f32 v[32:33], v[32:33], v[18:19], v[18:19] op_sel_hi:[1,0,0]
    v_pk_fma_f32 v[34:35], v[34:35], v[18:19], v[18:19] op_sel_hi:[1,0,0]
    v_pk_mul_f32 v[56:57], v[56:57], v[64:65]
    v_pk_mul_f32 v[58:59], v[58:59], v[66:67]
    v_pk_mul_f32 v[60:61], v[60:61], v[68:69]
    v_pk_mul_f32 v[62:63], v[62:63], v[70:71]
    v_rcp_f32 v28, v28
    v_rcp_f32 v29, v29
    v_rcp_f32 v30, v30
    v_rcp_f32 v31, v31
    v_rcp_f32 v32, v32
    v_rcp_f32 v33, v33
    v_rcp_f32 v34, v34
    v_rcp_f32 v35, v35
    s_nop 0
    v_pk_mul_f32 v[56:57], v[56:57], v[28:29]
    v_pk_mul_f32 v[58:59], v[58:59], v[30:31]
    v_pk_mul_f32 v[60:61], v[60:61], v[32:33]
    v_pk_mul_f32 v[62:63], v[62:63], v[34:35]
    v_cvt_pk_bf16_f32 v64, v56, v57
    v_cvt_pk_bf16_f32 v65, v58, v59
    v_cvt_pk_bf16_f32 v66, v60, v61
    v_cvt_pk_bf16_f32 v67, v62, v63
    s_add_u32 s25, s23, 98304
    buffer_store_dwordx4 v[64:67], v11, s[8:11], s25 offen sc1
    buffer_load_dwordx4 v[160:163], v4, s[8:11], s35 offen offset:1024
    v_pk_mul_f32 v[28:29], v[88:89], v[16:17] op_sel_hi:[1,0]
    v_pk_mul_f32 v[30:31], v[90:91], v[16:17] op_sel_hi:[1,0]
    v_pk_mul_f32 v[32:33], v[92:93], v[16:17] op_sel_hi:[1,0]
    v_pk_mul_f32 v[34:35], v[94:95], v[16:17] op_sel_hi:[1,0]
    v_exp_f32 v28, v28
    v_exp_f32 v29, v29
    v_exp_f32 v30, v30
    v_exp_f32 v31, v31
    v_exp_f32 v32, v32
    v_exp_f32 v33, v33
    v_exp_f32 v34, v34
    v_exp_f32 v35, v35
    buffer_load_dwordx4 v[164:167], v4, s[8:11], s35 offen offset:2048
    v_pk_fma_f32 v[20:21], v[20:21], v[14:15], v[14:15] op_sel_hi:[1,0,0]
    v_pk_fma_f32 v[22:23], v[22:23], v[14:15], v[14:15] op_sel_hi:[1,0,0]
    v_pk_fma_f32 v[24:25], v[24:25], v[14:15], v[14:15] op_sel_hi:[1,0,0]
    v_pk_fma_f32 v[26:27], v[26:27], v[14:15], v[14:15] op_sel_hi:[1,0,0]
    v_pk_mul_f32 v[72:73], v[72:73], v[80:81]
    v_pk_mul_f32 v[74:75], v[74:75], v[82:83]
    v_pk_mul_f32 v[76:77], v[76:77], v[84:85]
    v_pk_mul_f32 v[78:79], v[78:79], v[86:87]
    v_rcp_f32 v20, v20
    v_rcp_f32 v21, v21
    v_rcp_f32 v22, v22
    v_rcp_f32 v23, v23
    v_rcp_f32 v24, v24
    v_rcp_f32 v25, v25
    v_rcp_f32 v26, v26
    v_rcp_f32 v27, v27
    s_nop 0
    v_pk_mul_f32 v[72:73], v[72:73], v[20:21]
    v_pk_mul_f32 v[74:75], v[74:75], v[22:23]
    v_pk_mul_f32 v[76:77], v[76:77], v[24:25]
    v_pk_mul_f32 v[78:79], v[78:79], v[26:27]
    v_cvt_pk_bf16_f32 v80, v72, v73
    v_cvt_pk_bf16_f32 v81, v74, v75
    v_cvt_pk_bf16_f32 v82, v76, v77
    v_cvt_pk_bf16_f32 v83, v78, v79
    s_add_u32 s25, s23, 512
    buffer_store_dwordx4 v[80:83], v11, s[8:11], s25 offen sc1
    buffer_load_dwordx4 v[168:171], v4, s[8:11], s35 offen offset:3072
    v_pk_mul_f32 v[20:21], v[104:105], v[12:13] op_sel_hi:[1,0]
    v_pk_mul_f32 v[22:23], v[106:107], v[12:13] op_sel_hi:[1,0]
    v_pk_mul_f32 v[24:25], v[108:109], v[12:13] op_sel_hi:[1,0]
    v_pk_mul_f32 v[26:27], v[110:111], v[12:13] op_sel_hi:[1,0]
    v_exp_f32 v20, v20
    v_exp_f32 v21, v21
    v_exp_f32 v22, v22
    v_exp_f32 v23, v23
    v_exp_f32 v24, v24
    v_exp_f32 v25, v25
    v_exp_f32 v26, v26
    v_exp_f32 v27, v27
    buffer_load_dwordx4 v[172:175], v2, s[8:11], s35 offen offset:0
    v_pk_fma_f32 v[28:29], v[28:29], v[18:19], v[18:19] op_sel_hi:[1,0,0]
    v_pk_fma_f32 v[30:31], v[30:31], v[18:19], v[18:19] op_sel_hi:[1,0,0]
    v_pk_fma_f32 v[32:33], v[32:33], v[18:19], v[18:19] op_sel_hi:[1,0,0]
    v_pk_fma_f32 v[34:35], v[34:35], v[18:19], v[18:19] op_sel_hi:[1,0,0]
    v_pk_mul_f32 v[88:89], v[88:89], v[96:97]
    v_pk_mul_f32 v[90:91], v[90:91], v[98:99]
    v_pk_mul_f32 v[92:93], v[92:93], v[100:101]
    v_pk_mul_f32 v[94:95], v[94:95], v[102:103]
    v_rcp_f32 v28, v28
    v_rcp_f32 v29, v29
    v_rcp_f32 v30, v30
    v_rcp_f32 v31, v31
    v_rcp_f32 v32, v32
    v_rcp_f32 v33, v33
    v_rcp_f32 v34, v34
    v_rcp_f32 v35, v35
    s_nop 0
    v_pk_mul_f32 v[88:89], v[88:89], v[28:29]
    v_pk_mul_f32 v[90:91], v[90:91], v[30:31]
    v_pk_mul_f32 v[92:93], v[92:93], v[32:33]
    v_pk_mul_f32 v[94:95], v[94:95], v[34:35]
    v_cvt_pk_bf16_f32 v96, v88, v89
    v_cvt_pk_bf16_f32 v97, v90, v91
    v_cvt_pk_bf16_f32 v98, v92, v93
    v_cvt_pk_bf16_f32 v99, v94, v95
    s_add_u32 s25, s23, 98816
    buffer_store_dwordx4 v[96:99], v11, s[8:11], s25 offen sc1
    v_pk_mul_f32 v[28:29], v[120:121], v[16:17] op_sel_hi:[1,0]
    v_pk_mul_f32 v[30:31], v[122:123], v[16:17] op_sel_hi:[1,0]
    v_pk_mul_f32 v[32:33], v[124:125], v[16:17] op_sel_hi:[1,0]
    v_pk_mul_f32 v[34:35], v[126:127], v[16:17] op_sel_hi:[1,0]
    v_exp_f32 v28, v28
    v_exp_f32 v29, v29
    v_exp_f32 v30, v30
    v_exp_f32 v31, v31
    v_exp_f32 v32, v32
    v_exp_f32 v33, v33
    v_exp_f32 v34, v34
    v_exp_f32 v35, v35
    v_pk_fma_f32 v[20:21], v[20:21], v[14:15], v[14:15] op_sel_hi:[1,0,0]
    v_pk_fma_f32 v[22:23], v[22:23], v[14:15], v[14:15] op_sel_hi:[1,0,0]
    v_pk_fma_f32 v[24:25], v[24:25], v[14:15], v[14:15] op_sel_hi:[1,0,0]
    v_pk_fma_f32 v[26:27], v[26:27], v[14:15], v[14:15] op_sel_hi:[1,0,0]
    v_pk_mul_f32 v[104:105], v[104:105], v[112:113]
    v_pk_mul_f32 v[106:107], v[106:107], v[114:115]
    v_pk_mul_f32 v[108:109], v[108:109], v[116:117]
    v_pk_mul_f32 v[110:111], v[110:111], v[118:119]
    v_rcp_f32 v20, v20
    v_rcp_f32 v21, v21
    v_rcp_f32 v22, v22
    v_rcp_f32 v23, v23
    v_rcp_f32 v24, v24
    v_rcp_f32 v25, v25
    v_rcp_f32 v26, v26
    v_rcp_f32 v27, v27
    s_nop 0
    v_pk_mul_f32 v[104:105], v[104:105], v[20:21]
    v_pk_mul_f32 v[106:107], v[106:107], v[22:23]
    v_pk_mul_f32 v[108:109], v[108:109], v[24:25]
    v_pk_mul_f32 v[110:111], v[110:111], v[26:27]
    v_cvt_pk_bf16_f32 v112, v104, v105
    v_cvt_pk_bf16_f32 v113, v106, v107
    v_cvt_pk_bf16_f32 v114, v108, v109
    v_cvt_pk_bf16_f32 v115, v110, v111
    s_add_u32 s25, s23, 1024
    buffer_store_dwordx4 v[112:115], v11, s[8:11], s25 offen sc1
    s_nop 0
    v_pk_fma_f32 v[28:29], v[28:29], v[18:19], v[18:19] op_sel_hi:[1,0,0]
    v_pk_fma_f32 v[30:31], v[30:31], v[18:19], v[18:19] op_sel_hi:[1,0,0]
    v_pk_fma_f32 v[32:33], v[32:33], v[18:19], v[18:19] op_sel_hi:[1,0,0]
    v_pk_fma_f32 v[34:35], v[34:35], v[18:19], v[18:19] op_sel_hi:[1,0,0]
    v_pk_mul_f32 v[120:121], v[120:121], v[128:129]
    v_pk_mul_f32 v[122:123], v[122:123], v[130:131]
    v_pk_mul_f32 v[124:125], v[124:125], v[132:133]
    v_pk_mul_f32 v[126:127], v[126:127], v[134:135]
    v_rcp_f32 v28, v28
    v_rcp_f32 v29, v29
    v_rcp_f32 v30, v30
    v_rcp_f32 v31, v31
    v_rcp_f32 v32, v32
    v_rcp_f32 v33, v33
    v_rcp_f32 v34, v34
    v_rcp_f32 v35, v35
    s_nop 0
    v_pk_mul_f32 v[120:121], v[120:121], v[28:29]
    v_pk_mul_f32 v[122:123], v[122:123], v[30:31]
    v_pk_mul_f32 v[124:125], v[124:125], v[32:33]
    v_pk_mul_f32 v[126:127], v[126:127], v[34:35]
    v_cvt_pk_bf16_f32 v128, v120, v121
    v_cvt_pk_bf16_f32 v129, v122, v123
    v_cvt_pk_bf16_f32 v130, v124, v125
    v_cvt_pk_bf16_f32 v131, v126, v127
    s_add_u32 s25, s23, 99328
    buffer_store_dwordx4 v[128:131], v11, s[8:11], s25 offen sc1
    s_lshl_b32 s23, s19, 1
    s_add_u32 s23, s23, s18
    s_lshl_b32 s23, s23, 5
    s_lshl_b32 s24, s20, 1
    s_add_u32 s23, s23, s24
    s_add_u32 s23, s23, s17
    s_lshl_b32 s23, s23, 7
    s_add_u32 s23, s23, 24117248
    v_mov_b32 v3, s78
    s_mov_b64 exec, 1
    s_waitcnt vmcnt(0)
    buffer_store_dword v3, off, s[8:11], s23 sc1
    s_mov_b64 exec, -1
    s_mul_i32 s22, s21, 6
    s_add_u32 s23, s21, 0
    s_and_b32 s23, s23, 3
    s_lshl_b32 s24, s36, 2
    s_add_u32 s23, s23, s24
    s_mul_i32 s23, s23, 48
    s_add_u32 s23, s23, s22
    s_lshl_b32 s23, s23, 10
    s_add_u32 s40, s23, 10485760
    s_add_u32 s23, s21, 1
    s_and_b32 s23, s23, 3
    s_lshl_b32 s24, s36, 2
    s_add_u32 s23, s23, s24
    s_mul_i32 s23, s23, 48
    s_add_u32 s23, s23, s22
    s_lshl_b32 s23, s23, 10
    s_add_u32 s41, s23, 10485760
    s_add_u32 s23, s21, 2
    s_and_b32 s23, s23, 3
    s_lshl_b32 s24, s36, 2
    s_add_u32 s23, s23, s24
    s_mul_i32 s23, s23, 48
    s_add_u32 s23, s23, s22
    s_lshl_b32 s23, s23, 10
    s_add_u32 s42, s23, 10485760
    s_add_u32 s23, s21, 3
    s_and_b32 s23, s23, 3
    s_lshl_b32 s24, s36, 2
    s_add_u32 s23, s23, s24
    s_mul_i32 s23, s23, 48
    s_add_u32 s23, s23, s22
    s_lshl_b32 s23, s23, 10
    s_add_u32 s43, s23, 10485760
    s_lshl_b32 s23, s36, 5
    s_lshl_b32 s24, s21, 2
    s_add_u32 s23, s23, s24
    s_lshl_b32 s23, s23, 7
    s_add_u32 s39, s23, 24117248
    v_and_b32 v3, 3, v1
    v_lshlrev_b32 v3, 7, v3
    s_add_u32 s23, s21, 0
    s_and_b32 s23, s23, 3
    s_sub_u32 s24, s21, s23
    s_sub_u32 s24, s24, 1
    s_and_b32 s24, s24, 7
    s_mul_i32 s24, s24, 3072
    s_mul_i32 s23, s23, 21504
    s_add_u32 s44, s23, s24
    s_add_u32 s23, s21, 0
    s_and_b32 s23, s23, 3
    s_sub_u32 s24, s21, s23
    s_sub_u32 s24, s24, 5
    s_and_b32 s24, s24, 7
    s_mul_i32 s24, s24, 2048
    s_mul_i32 s23, s23, 14336
    s_add_u32 s45, s23, s24
    s_add_u32 s45, s45, 86016
    s_add_u32 s23, s21, 1
    s_and_b32 s23, s23, 3
    s_sub_u32 s24, s21, s23
    s_sub_u32 s24, s24, 1
    s_and_b32 s24, s24, 7
    s_mul_i32 s24, s24, 3072
    s_mul_i32 s23, s23, 21504
    s_add_u32 s46, s23, s24
    s_add_u32 s23, s21, 1
    s_and_b32 s23, s23, 3
    s_sub_u32 s24, s21, s23
    s_sub_u32 s24, s24, 5
    s_and_b32 s24, s24, 7
    s_mul_i32 s24, s24, 2048
    s_mul_i32 s23, s23, 14336
    s_add_u32 s47, s23, s24
    s_add_u32 s47, s47, 86016
    s_add_u32 s23, s21, 2
    s_and_b32 s23, s23, 3
    s_sub_u32 s24, s21, s23
    s_sub_u32 s24, s24, 1
    s_and_b32 s24, s24, 7
    s_mul_i32 s24, s24, 3072
    s_mul_i32 s23, s23, 21504
    s_add_u32 s48, s23, s24
    s_add_u32 s23, s21, 2
    s_and_b32 s23, s23, 3
    s_sub_u32 s24, s21, s23
    s_sub_u32 s24, s24, 5
    s_and_b32 s24, s24, 7
    s_mul_i32 s24, s24, 2048
    s_mul_i32 s23, s23, 14336
    s_add_u32 s49, s23, s24
    s_add_u32 s49, s49, 86016
    s_add_u32 s23, s21, 3
    s_and_b32 s23, s23, 3
    s_sub_u32 s24, s21, s23
    s_sub_u32 s24, s24, 1
    s_and_b32 s24, s24, 7
    s_mul_i32 s24, s24, 3072
    s_mul_i32 s23, s23, 21504
    s_add_u32 s50, s23, s24
    s_add_u32 s23, s21, 3
    s_and_b32 s23, s23, 3
    s_sub_u32 s24, s21, s23
    s_sub_u32 s24, s24, 5
    s_and_b32 s24, s24, 7
    s_mul_i32 s24, s24, 2048
    s_mul_i32 s23, s23, 14336
    s_add_u32 s51, s23, s24
    s_add_u32 s51, s51, 86016
    s_and_b32 s53, s21, 3
    s_mul_i32 s52, s53, 21504
    v_lshrrev_b32 v6, 4, v1
    v_and_b32 v7, 15, v1
    v_lshrrev_b32 v8, 1, v6
    v_lshlrev_b32 v8, 9, v8
    v_lshl_add_u32 v8, v7, 4, v8
    v_and_b32 v5, 1, v6
    v_lshl_add_u32 v5, v5, 3, v8
    v_mul_u32_u24 v8, 1280, v7
    v_lshl_add_u32 v6, v6, 3, v8
    v_lshlrev_b32 v7, 2, v7
    s_lshl_b32 s22, s36, 1
    s_lshr_b32 s23, s53, 1
    s_add_u32 s22, s22, s23
    s_mul_i32 s22, s22, 40
    s_mul_i32 s23, s37, 5
    s_add_u32 s22, s22, s23
    s_add_u32 s22, s22, 0
    s_lshl_b32 s22, s22, 10
    s_and_b32 s23, s53, 1
    s_lshl_b32 s23, s23, 8
    s_add_u32 s22, s22, s23
    s_add_u32 s54, s22, 7864320
    s_lshl_b32 s22, s36, 2
    s_add_u32 s22, s22, s53
    s_lshl_b32 s23, s22, 6
    s_add_u32 s55, s23, 16777216
    s_mul_i32 s56, s22, 20480
    s_mul_i32 s23, s37, 160
    s_add_u32 s56, s56, s23
    s_mov_b32 s57, 20000
k1_kernel_poll19:
    buffer_load_dword v8, v3, s[8:11], s39 offen sc1
    s_sub_u32 s57, s57, 1
    s_cmp_eq_u32 s57, 0
    s_cbranch_scc1 k1_kernel_got20
    s_waitcnt vmcnt(0)
    v_cmp_ne_u32 vcc, s78, v8
    s_cmp_lg_u64 vcc, 0
    s_cbranch_scc1 k1_kernel_poll19
k1_kernel_got20:
    s_waitcnt vmcnt(0)
    buffer_load_dwordx4 v[8:11], v4, s[8:11], s40 offen offset:0
    buffer_load_dwordx4 v[12:15], v4, s[8:11], s41 offen offset:0
    buffer_load_dwordx4 v[16:19], v4, s[8:11], s42 offen offset:0
    buffer_load_dwordx4 v[20:23], v4, s[8:11], s43 offen offset:0
    buffer_load_dwordx4 v[24:27], v4, s[8:11], s40 offen offset:1024
    buffer_load_dwordx4 v[28:31], v4, s[8:11], s41 offen offset:1024
    buffer_load_dwordx4 v[32:35], v4, s[8:11], s42 offen offset:1024
    buffer_load_dwordx4 v[36:39], v4, s[8:11], s43 offen offset:1024
    buffer_load_dwordx4 v[120:123], v4, s[8:11], s40 offen offset:2048
    buffer_load_dwordx4 v[124:127], v4, s[8:11], s41 offen offset:2048
    buffer_load_dwordx4 v[128:131], v4, s[8:11], s42 offen offset:2048
    buffer_load_dwordx4 v[132:135], v4, s[8:11], s43 offen offset:2048
    s_waitcnt vmcnt(8)
    v_mfma_f32_16x16x32_bf16 v[40:43], v[136:139], v[8:11], 0
    v_mfma_f32_16x16x32_bf16 v[44:47], v[140:143], v[8:11], 0
    v_mfma_f32_16x16x32_bf16 v[48:51], v[144:147], v[8:11], 0
    v_mfma_f32_16x16x32_bf16 v[52:55], v[148:151], v[8:11], 0
    v_mfma_f32_16x16x32_bf16 v[56:59], v[152:155], v[8:11], 0
    buffer_load_dwordx4 v[8:11], v4, s[8:11], s40 offen offset:3072
    v_mfma_f32_16x16x32_bf16 v[60:63], v[136:139], v[12:15], 0
    v_mfma_f32_16x16x32_bf16 v[64:67], v[140:143], v[12:15], 0
    v_mfma_f32_16x16x32_bf16 v[68:71], v[144:147], v[12:15], 0
    v_mfma_f32_16x16x32_bf16 v[72:75], v[148:151], v[12:15], 0
    v_mfma_f32_16x16x32_bf16 v[76:79], v[152:155], v[12:15], 0
    buffer_load_dwordx4 v[12:15], v4, s[8:11], s41 offen offset:3072
    v_mfma_f32_16x16x32_bf16 v[80:83], v[136:139], v[16:19], 0
    v_mfma_f32_16x16x32_bf16 v[84:87], v[140:143], v[16:19], 0
    v_mfma_f32_16x16x32_bf16 v[88:91], v[144:147], v[16:19], 0
    v_mfma_f32_16x16x32_bf16 v[92:95], v[148:151], v[16:19], 0
    v_mfma_f32_16x16x32_bf16 v[96:99], v[152:155], v[16:19], 0
    buffer_load_dwordx4 v[16:19], v4, s[8:11], s42 offen offset:3072
    v_mfma_f32_16x16x32_bf16 v[100:103], v[136:139], v[20:23], 0
    v_mfma_f32_16x16x32_bf16 v[104:107], v[140:143], v[20:23], 0
    v_mfma_f32_16x16x32_bf16 v[108:111], v[144:147], v[20:23], 0
    v_mfma_f32_16x16x32_bf16 v[112:115], v[148:151], v[20:23], 0
    v_mfma_f32_16x16x32_bf16 v[116:119], v[152:155], v[20:23], 0
    buffer_load_dwordx4 v[20:23], v4, s[8:11], s43 offen offset:3072
    s_waitcnt vmcnt(8)
    v_mfma_f32_16x16x32_bf16 v[40:43], v[156:159], v[24:27], v[40:43]
    v_mfma_f32_16x16x32_bf16 v[44:47], v[160:163], v[24:27], v[44:47]
    v_mfma_f32_16x16x32_bf16 v[48:51], v[164:167], v[24:27], v[48:51]
    v_mfma_f32_16x16x32_bf16 v[52:55], v[168:171], v[24:27], v[52:55]
    v_mfma_f32_16x16x32_bf16 v[56:59], v[172:175], v[24:27], v[56:59]
    buffer_load_dwordx4 v[136:139], v2, s[8:11], s40 offen offset:0
    v_mfma_f32_16x16x32_bf16 v[60:63], v[156:159], v[28:31], v[60:63]
    v_mfma_f32_16x16x32_bf16 v[64:67], v[160:163], v[28:31], v[64:67]
    v_mfma_f32_16x16x32_bf16 v[68:71], v[164:167], v[28:31], v[68:71]
    v_mfma_f32_16x16x32_bf16 v[72:75], v[168:171], v[28:31], v[72:75]
    v_mfma_f32_16x16x32_bf16 v[76:79], v[172:175], v[28:31], v[76:79]
    buffer_load_dwordx4 v[140:143], v2, s[8:11], s41 offen offset:0
    v_mfma_f32_16x16x32_bf16 v[80:83], v[156:159], v[32:35], v[80:83]
    v_mfma_f32_16x16x32_bf16 v[84:87], v[160:163], v[32:35], v[84:87]
    v_mfma_f32_16x16x32_bf16 v[88:91], v[164:167], v[32:35], v[88:91]
    v_mfma_f32_16x16x32_bf16 v[92:95], v[168:171], v[32:35], v[92:95]
    v_mfma_f32_16x16x32_bf16 v[96:99], v[172:175], v[32:35], v[96:99]
    buffer_load_dwordx4 v[144:147], v2, s[8:11], s42 offen offset:0
    v_mfma_f32_16x16x32_bf16 v[100:103], v[156:159], v[36:39], v[100:103]
    v_mfma_f32_16x16x32_bf16 v[104:107], v[160:163], v[36:39], v[104:107]
    v_mfma_f32_16x16x32_bf16 v[108:111], v[164:167], v[36:39], v[108:111]
    v_mfma_f32_16x16x32_bf16 v[112:115], v[168:171], v[36:39], v[112:115]
    v_mfma_f32_16x16x32_bf16 v[116:119], v[172:175], v[36:39], v[116:119]
    buffer_load_dwordx4 v[148:151], v2, s[8:11], s43 offen offset:0
    s_waitcnt vmcnt(8)
    v_mfma_f32_16x16x32_bf16 v[40:43], v[176:179], v[120:123], v[40:43]
    v_mfma_f32_16x16x32_bf16 v[44:47], v[180:183], v[120:123], v[44:47]
    v_mfma_f32_16x16x32_bf16 v[48:51], v[184:187], v[120:123], v[48:51]
    v_mfma_f32_16x16x32_bf16 v[52:55], v[188:191], v[120:123], v[52:55]
    v_mfma_f32_16x16x32_bf16 v[56:59], v[192:195], v[120:123], v[56:59]
    buffer_load_dwordx4 v[24:27], v2, s[8:11], s40 offen offset:1024
    buffer_load_dwordx4 v[28:31], v2, s[8:11], s41 offen offset:1024
    buffer_load_dwordx4 v[32:35], v2, s[8:11], s42 offen offset:1024
    buffer_load_dwordx4 v[36:39], v2, s[8:11], s43 offen offset:1024
    v_mfma_f32_16x16x32_bf16 v[60:63], v[176:179], v[124:127], v[60:63]
    v_mfma_f32_16x16x32_bf16 v[64:67], v[180:183], v[124:127], v[64:67]
    v_mfma_f32_16x16x32_bf16 v[68:71], v[184:187], v[124:127], v[68:71]
    v_mfma_f32_16x16x32_bf16 v[72:75], v[188:191], v[124:127], v[72:75]
    v_mfma_f32_16x16x32_bf16 v[76:79], v[192:195], v[124:127], v[76:79]
    buffer_load_dwordx2 v[156:157], v5, s[8:11], s54 offen offset:0
    buffer_load_dwordx2 v[158:159], v5, s[8:11], s54 offen offset:1024
    buffer_load_dwordx2 v[160:161], v5, s[8:11], s54 offen offset:2048
    buffer_load_dword v164, v7, s[8:11], s55 offen
    v_mfma_f32_16x16x32_bf16 v[80:83], v[176:179], v[128:131], v[80:83]
    v_mfma_f32_16x16x32_bf16 v[84:87], v[180:183], v[128:131], v[84:87]
    v_mfma_f32_16x16x32_bf16 v[88:91], v[184:187], v[128:131], v[88:91]
    v_mfma_f32_16x16x32_bf16 v[92:95], v[188:191], v[128:131], v[92:95]
    v_mfma_f32_16x16x32_bf16 v[96:99], v[192:195], v[128:131], v[96:99]
    v_mfma_f32_16x16x32_bf16 v[100:103], v[176:179], v[132:135], v[100:103]
    v_mfma_f32_16x16x32_bf16 v[104:107], v[180:183], v[132:135], v[104:107]
    v_mfma_f32_16x16x32_bf16 v[108:111], v[184:187], v[132:135], v[108:111]
    v_mfma_f32_16x16x32_bf16 v[112:115], v[188:191], v[132:135], v[112:115]
    v_mfma_f32_16x16x32_bf16 v[116:119], v[192:195], v[132:135], v[116:119]
    s_waitcnt vmcnt(12)
    v_mfma_f32_16x16x32_bf16 v[40:43], v[196:199], v[8:11], v[40:43]
    v_mfma_f32_16x16x32_bf16 v[44:47], v[200:203], v[8:11], v[44:47]
    v_mfma_f32_16x16x32_bf16 v[48:51], v[204:207], v[8:11], v[48:51]
    v_mfma_f32_16x16x32_bf16 v[52:55], v[208:211], v[8:11], v[52:55]
    v_mfma_f32_16x16x32_bf16 v[56:59], v[212:215], v[8:11], v[56:59]
    v_mfma_f32_16x16x32_bf16 v[60:63], v[196:199], v[12:15], v[60:63]
    v_mfma_f32_16x16x32_bf16 v[64:67], v[200:203], v[12:15], v[64:67]
    v_mfma_f32_16x16x32_bf16 v[68:71], v[204:207], v[12:15], v[68:71]
    v_mfma_f32_16x16x32_bf16 v[72:75], v[208:211], v[12:15], v[72:75]
    v_mfma_f32_16x16x32_bf16 v[76:79], v[212:215], v[12:15], v[76:79]
    v_mfma_f32_16x16x32_bf16 v[80:83], v[196:199], v[16:19], v[80:83]
    v_mfma_f32_16x16x32_bf16 v[84:87], v[200:203], v[16:19], v[84:87]
    v_mfma_f32_16x16x32_bf16 v[88:91], v[204:207], v[16:19], v[88:91]
    v_mfma_f32_16x16x32_bf16 v[92:95], v[208:211], v[16:19], v[92:95]
    v_mfma_f32_16x16x32_bf16 v[96:99], v[212:215], v[16:19], v[96:99]
    v_mfma_f32_16x16x32_bf16 v[100:103], v[196:199], v[20:23], v[100:103]
    v_mfma_f32_16x16x32_bf16 v[104:107], v[200:203], v[20:23], v[104:107]
    v_mfma_f32_16x16x32_bf16 v[108:111], v[204:207], v[20:23], v[108:111]
    v_mfma_f32_16x16x32_bf16 v[112:115], v[208:211], v[20:23], v[112:115]
    v_mfma_f32_16x16x32_bf16 v[116:119], v[212:215], v[20:23], v[116:119]
    s_waitcnt vmcnt(8)
    v_mfma_f32_16x16x32_bf16 v[40:43], v[216:219], v[136:139], v[40:43]
    v_mfma_f32_16x16x32_bf16 v[44:47], v[220:223], v[136:139], v[44:47]
    v_mfma_f32_16x16x32_bf16 v[48:51], v[224:227], v[136:139], v[48:51]
    v_mfma_f32_16x16x32_bf16 v[52:55], v[228:231], v[136:139], v[52:55]
    v_mfma_f32_16x16x32_bf16 v[56:59], v[232:235], v[136:139], v[56:59]
    v_mfma_f32_16x16x32_bf16 v[60:63], v[216:219], v[140:143], v[60:63]
    v_mfma_f32_16x16x32_bf16 v[64:67], v[220:223], v[140:143], v[64:67]
    v_mfma_f32_16x16x32_bf16 v[68:71], v[224:227], v[140:143], v[68:71]
    v_mfma_f32_16x16x32_bf16 v[72:75], v[228:231], v[140:143], v[72:75]
    v_mfma_f32_16x16x32_bf16 v[76:79], v[232:235], v[140:143], v[76:79]
    v_mfma_f32_16x16x32_bf16 v[80:83], v[216:219], v[144:147], v[80:83]
    v_mfma_f32_16x16x32_bf16 v[84:87], v[220:223], v[144:147], v[84:87]
    v_mfma_f32_16x16x32_bf16 v[88:91], v[224:227], v[144:147], v[88:91]
    v_mfma_f32_16x16x32_bf16 v[92:95], v[228:231], v[144:147], v[92:95]
    v_mfma_f32_16x16x32_bf16 v[96:99], v[232:235], v[144:147], v[96:99]
    v_mfma_f32_16x16x32_bf16 v[100:103], v[216:219], v[148:151], v[100:103]
    v_mfma_f32_16x16x32_bf16 v[104:107], v[220:223], v[148:151], v[104:107]
    v_mfma_f32_16x16x32_bf16 v[108:111], v[224:227], v[148:151], v[108:111]
    v_mfma_f32_16x16x32_bf16 v[112:115], v[228:231], v[148:151], v[112:115]
    v_mfma_f32_16x16x32_bf16 v[116:119], v[232:235], v[148:151], v[116:119]
    s_waitcnt vmcnt(4)
    v_mfma_f32_16x16x32_bf16 v[40:43], v[236:239], v[24:27], v[40:43]
    v_mfma_f32_16x16x32_bf16 v[44:47], v[240:243], v[24:27], v[44:47]
    v_mfma_f32_16x16x32_bf16 v[48:51], v[244:247], v[24:27], v[48:51]
    v_mfma_f32_16x16x32_bf16 v[52:55], v[248:251], v[24:27], v[52:55]
    v_mfma_f32_16x16x32_bf16 v[56:59], v[252:255], v[24:27], v[56:59]
    v_mfma_f32_16x16x32_bf16 v[60:63], v[236:239], v[28:31], v[60:63]
    v_mfma_f32_16x16x32_bf16 v[64:67], v[240:243], v[28:31], v[64:67]
    v_mfma_f32_16x16x32_bf16 v[68:71], v[244:247], v[28:31], v[68:71]
    v_mfma_f32_16x16x32_bf16 v[72:75], v[248:251], v[28:31], v[72:75]
    v_mfma_f32_16x16x32_bf16 v[76:79], v[252:255], v[28:31], v[76:79]
    v_mfma_f32_16x16x32_bf16 v[80:83], v[236:239], v[32:35], v[80:83]
    v_mfma_f32_16x16x32_bf16 v[84:87], v[240:243], v[32:35], v[84:87]
    v_mfma_f32_16x16x32_bf16 v[88:91], v[244:247], v[32:35], v[88:91]
    v_mfma_f32_16x16x32_bf16 v[92:95], v[248:251], v[32:35], v[92:95]
    v_mfma_f32_16x16x32_bf16 v[96:99], v[252:255], v[32:35], v[96:99]
    v_mfma_f32_16x16x32_bf16 v[100:103], v[236:239], v[36:39], v[100:103]
    v_mfma_f32_16x16x32_bf16 v[104:107], v[240:243], v[36:39], v[104:107]
    v_mfma_f32_16x16x32_bf16 v[108:111], v[244:247], v[36:39], v[108:111]
    v_mfma_f32_16x16x32_bf16 v[112:115], v[248:251], v[36:39], v[112:115]
    v_mfma_f32_16x16x32_bf16 v[116:119], v[252:255], v[36:39], v[116:119]
    s_nop 4
    v_add_u32 v122, s46, v4
    ds_write_b128 v122, v[60:63] offset:0
    ds_write_b128 v122, v[64:67] offset:1024
    ds_write_b128 v122, v[68:71] offset:2048
    v_add_u32 v123, s47, v4
    ds_write_b128 v123, v[72:75] offset:0
    ds_write_b128 v123, v[76:79] offset:1024
    v_add_u32 v124, s48, v4
    ds_write_b128 v124, v[80:83] offset:0
    ds_write_b128 v124, v[84:87] offset:1024
    ds_write_b128 v124, v[88:91] offset:2048
    v_add_u32 v125, s49, v4
    ds_write_b128 v125, v[92:95] offset:0
    ds_write_b128 v125, v[96:99] offset:1024
    v_add_u32 v126, s50, v4
    ds_write_b128 v126, v[100:103] offset:0
    ds_write_b128 v126, v[104:107] offset:1024
    ds_write_b128 v126, v[108:111] offset:2048
    v_add_u32 v127, s51, v4
    ds_write_b128 v127, v[112:115] offset:0
    ds_write_b128 v127, v[116:119] offset:1024
    v_add_u32 v121, s45, v4
    ds_write_b128 v121, v[52:55] offset:0
    ds_write_b128 v121, v[56:59] offset:1024
    v_add_u32 v128, s52, v4
    s_waitcnt lgkmcnt(0)
    s_barrier
    ds_read_b128 v[168:171], v128 offset:0
    ds_read_b128 v[172:175], v128 offset:1024
    ds_read_b128 v[176:179], v128 offset:2048
    ds_read_b128 v[180:183], v128 offset:3072
    ds_read_b128 v[184:187], v128 offset:4096
    ds_read_b128 v[188:191], v128 offset:5120
    ds_read_b128 v[192:195], v128 offset:6144
    ds_read_b128 v[196:199], v128 offset:7168
    ds_read_b128 v[200:203], v128 offset:8192
    ds_read_b128 v[204:207], v128 offset:9216
    ds_read_b128 v[208:211], v128 offset:10240
    ds_read_b128 v[212:215], v128 offset:11264
    ds_read_b128 v[216:219], v128 offset:12288
    ds_read_b128 v[220:223], v128 offset:13312
    ds_read_b128 v[224:227], v128 offset:14336
    ds_read_b128 v[228:231], v128 offset:15360
    ds_read_b128 v[232:235], v128 offset:16384
    ds_read_b128 v[236:239], v128 offset:17408
    ds_read_b128 v[240:243], v128 offset:18432
    ds_read_b128 v[244:247], v128 offset:19456
    ds_read_b128 v[248:251], v128 offset:20480
    s_waitcnt vmcnt(0)
    v_lshlrev_b32 v8, 16, v156
    v_and_b32 v9, 0xffff0000, v156
    v_lshlrev_b32 v10, 16, v157
    v_and_b32 v11, 0xffff0000, v157
    v_lshlrev_b32 v12, 16, v158
    v_and_b32 v13, 0xffff0000, v158
    v_lshlrev_b32 v14, 16, v159
    v_and_b32 v15, 0xffff0000, v159
    v_lshlrev_b32 v16, 16, v160
    v_and_b32 v17, 0xffff0000, v160
    v_lshlrev_b32 v18, 16, v161
    v_and_b32 v19, 0xffff0000, v161
    v_pk_add_f32 v[8:9], v[8:9], v[164:165] op_sel_hi:[1,0]
    v_pk_add_f32 v[10:11], v[10:11], v[164:165] op_sel_hi:[1,0]
    v_pk_add_f32 v[12:13], v[12:13], v[164:165] op_sel_hi:[1,0]
    v_pk_add_f32 v[14:15], v[14:15], v[164:165] op_sel_hi:[1,0]
    v_pk_add_f32 v[16:17], v[16:17], v[164:165] op_sel_hi:[1,0]
    v_pk_add_f32 v[18:19], v[18:19], v[164:165] op_sel_hi:[1,0]
    v_pk_add_f32 v[8:9], v[8:9], v[40:41]
    v_pk_add_f32 v[10:11], v[10:11], v[42:43]
    v_pk_add_f32 v[12:13], v[12:13], v[44:45]
    v_pk_add_f32 v[14:15], v[14:15], v[46:47]
    v_pk_add_f32 v[16:17], v[16:17], v[48:49]
    v_pk_add_f32 v[18:19], v[18:19], v[50:51]
    s_waitcnt lgkmcnt(15)
    v_pk_add_f32 v[168:169], v[168:169], v[180:181]
    v_pk_add_f32 v[170:171], v[170:171], v[182:183]
    v_pk_add_f32 v[172:173], v[172:173], v[184:185]
    v_pk_add_f32 v[174:175], v[174:175], v[186:187]
    v_pk_add_f32 v[176:177], v[176:177], v[188:189]
    v_pk_add_f32 v[178:179], v[178:179], v[190:191]
    s_waitcnt lgkmcnt(12)
    v_pk_add_f32 v[8:9], v[8:9], v[192:193]
    v_pk_add_f32 v[10:11], v[10:11], v[194:195]
    v_pk_add_f32 v[12:13], v[12:13], v[196:197]
    v_pk_add_f32 v[14:15], v[14:15], v[198:199]
    v_pk_add_f32 v[16:17], v[16:17], v[200:201]
    v_pk_add_f32 v[18:19], v[18:19], v[202:203]
    s_waitcnt lgkmcnt(9)
    v_pk_add_f32 v[168:169], v[168:169], v[204:205]
    v_pk_add_f32 v[170:171], v[170:171], v[206:207]
    v_pk_add_f32 v[172:173], v[172:173], v[208:209]
    v_pk_add_f32 v[174:175], v[174:175], v[210:211]
    v_pk_add_f32 v[176:177], v[176:177], v[212:213]
    v_pk_add_f32 v[178:179], v[178:179], v[214:215]
    s_waitcnt lgkmcnt(6)
    v_pk_add_f32 v[8:9], v[8:9], v[216:217]
    v_pk_add_f32 v[10:11], v[10:11], v[218:219]
    v_pk_add_f32 v[12:13], v[12:13], v[220:221]
    v_pk_add_f32 v[14:15], v[14:15], v[222:223]
    v_pk_add_f32 v[16:17], v[16:17], v[224:225]
    v_pk_add_f32 v[18:19], v[18:19], v[226:227]
    s_waitcnt lgkmcnt(3)
    v_pk_add_f32 v[168:169], v[168:169], v[228:229]
    v_pk_add_f32 v[170:171], v[170:171], v[230:231]
    v_pk_add_f32 v[172:173], v[172:173], v[232:233]
    v_pk_add_f32 v[174:175], v[174:175], v[234:235]
    v_pk_add_f32 v[176:177], v[176:177], v[236:237]
    v_pk_add_f32 v[178:179], v[178:179], v[238:239]
    s_waitcnt lgkmcnt(0)
    v_pk_add_f32 v[8:9], v[8:9], v[240:241]
    v_pk_add_f32 v[10:11], v[10:11], v[242:243]
    v_pk_add_f32 v[12:13], v[12:13], v[244:245]
    v_pk_add_f32 v[14:15], v[14:15], v[246:247]
    v_pk_add_f32 v[16:17], v[16:17], v[248:249]
    v_pk_add_f32 v[18:19], v[18:19], v[250:251]
    v_pk_add_f32 v[8:9], v[8:9], v[168:169]
    v_pk_add_f32 v[10:11], v[10:11], v[170:171]
    v_pk_add_f32 v[12:13], v[12:13], v[172:173]
    v_pk_add_f32 v[14:15], v[14:15], v[174:175]
    v_pk_add_f32 v[16:17], v[16:17], v[176:177]
    v_pk_add_f32 v[18:19], v[18:19], v[178:179]
    v_cvt_pk_bf16_f32 v24, v8, v9
    v_cvt_pk_bf16_f32 v25, v10, v11
    buffer_store_dwordx2 v[24:25], v6, s[12:15], s56 offen offset:0
    v_cvt_pk_bf16_f32 v26, v12, v13
    v_cvt_pk_bf16_f32 v27, v14, v15
    buffer_store_dwordx2 v[26:27], v6, s[12:15], s56 offen offset:32
    v_cvt_pk_bf16_f32 v28, v16, v17
    v_cvt_pk_bf16_f32 v29, v18, v19
    buffer_store_dwordx2 v[28:29], v6, s[12:15], s56 offen offset:64
    s_endpgm
k345_prod:
    v_lshlrev_b32 v8, 7, v1
    v_min_u32 v9, 25, v1
    v_add_u32 v9, 64, v9
    v_lshlrev_b32 v9, 7, v9
    s_mov_b32 s22, 24707072
    s_mov_b32 s57, 20000
k1_kernel_poll21:
    buffer_load_dword v10, v8, s[8:11], s22 offen sc1
    buffer_load_dword v11, v9, s[8:11], s22 offen sc1
    s_sub_u32 s57, s57, 1
    s_cmp_eq_u32 s57, 0
    s_cbranch_scc1 k1_kernel_got22
    s_waitcnt vmcnt(0)
    v_cmp_ne_u32 vcc, s78, v10
    s_mov_b64 s[76:77], vcc
    v_cmp_ne_u32 vcc, s78, v11
    s_or_b64 vcc, vcc, s[76:77]
    s_cmp_lg_u64 vcc, 0
    s_cbranch_scc1 k1_kernel_poll21
k1_kernel_got22:
    s_waitcnt vmcnt(0)
    s_mov_b32 s34, 0
    s_mov_b32 s34, 0
    s_add_u32 m0, s28, 0
    s_mul_i32 s22, s34, 12288
    s_add_u32 s22, s22, s26
    buffer_load_dwordx4 v4, s[8:11], s22 offen offset:0 lds
    buffer_load_dwordx4 v4, s[8:11], s22 offen offset:1024 lds
    buffer_load_dwordx4 v4, s[8:11], s22 offen offset:2048 lds
    s_mov_b32 s34, 1
    s_add_u32 m0, s28, 20480
    s_mul_i32 s22, s34, 12288
    s_add_u32 s22, s22, s26
    buffer_load_dwordx4 v4, s[8:11], s22 offen offset:0 lds
    buffer_load_dwordx4 v4, s[8:11], s22 offen offset:1024 lds
    buffer_load_dwordx4 v4, s[8:11], s22 offen offset:2048 lds
    s_mov_b32 s34, 2
    s_add_u32 m0, s28, 40960
    s_mul_i32 s22, s34, 12288
    s_add_u32 s22, s22, s26
    buffer_load_dwordx4 v4, s[8:11], s22 offen offset:0 lds
    buffer_load_dwordx4 v4, s[8:11], s22 offen offset:1024 lds
    buffer_load_dwordx4 v4, s[8:11], s22 offen offset:2048 lds
    s_mov_b32 s34, 3
    s_add_u32 m0, s28, 61440
    s_mul_i32 s22, s34, 12288
    s_add_u32 s22, s22, s26
    buffer_load_dwordx4 v4, s[8:11], s22 offen offset:0 lds
    buffer_load_dwordx4 v4, s[8:11], s22 offen offset:1024 lds
    buffer_load_dwordx4 v4, s[8:11], s22 offen offset:2048 lds
    s_lshl_b32 s23, s19, 1
    s_lshr_b32 s24, s16, 1
    s_add_u32 s23, s23, s24
    s_mul_i32 s23, s23, 2560
    s_add_u32 s39, s23, 24248320
    v_min_u32 v3, 19, v1
    v_lshlrev_b32 v3, 7, v3
    s_mov_b32 s57, 20000
k1_kernel_poll23:
    buffer_load_dword v8, v3, s[8:11], s39 offen sc1
    s_sub_u32 s57, s57, 1
    s_cmp_eq_u32 s57, 0
    s_cbranch_scc1 k1_kernel_got24
    s_waitcnt vmcnt(0)
    v_cmp_ne_u32 vcc, s78, v8
    s_cmp_lg_u64 vcc, 0
    s_cbranch_scc1 k1_kernel_poll23
k1_kernel_got24:
    s_waitcnt vmcnt(0)
    s_mov_b32 s34, 0
    s_add_u32 m0, s29, 0
    s_lshl_b32 s22, s34, 11
    s_add_u32 s22, s22, s27
    buffer_load_dwordx4 v4, s[8:11], s22 offen offset:0 lds
    buffer_load_dwordx4 v4, s[8:11], s22 offen offset:1024 lds
    s_add_u32 s34, s34, 1
    s_cmp_eq_u32 s34, 20
    s_cselect_b32 s34, 0, s34
    s_mov_b32 s34, 1
    s_add_u32 m0, s29, 20480
    s_lshl_b32 s22, s34, 11
    s_add_u32 s22, s22, s27
    buffer_load_dwordx4 v4, s[8:11], s22 offen offset:0 lds
    buffer_load_dwordx4 v4, s[8:11], s22 offen offset:1024 lds
    s_add_u32 s34, s34, 1
    s_cmp_eq_u32 s34, 20
    s_cselect_b32 s34, 0, s34
    s_mov_b32 s34, 2
    s_add_u32 m0, s29, 40960
    s_lshl_b32 s22, s34, 11
    s_add_u32 s22, s22, s27
    buffer_load_dwordx4 v4, s[8:11], s22 offen offset:0 lds
    buffer_load_dwordx4 v4, s[8:11], s22 offen offset:1024 lds
    s_add_u32 s34, s34, 1
    s_cmp_eq_u32 s34, 20
    s_cselect_b32 s34, 0, s34
    s_mov_b32 s34, 3
    s_add_u32 m0, s29, 61440
    s_lshl_b32 s22, s34, 11
    s_add_u32 s22, s22, s27
    buffer_load_dwordx4 v4, s[8:11], s22 offen offset:0 lds
    buffer_load_dwordx4 v4, s[8:11], s22 offen offset:1024 lds
    s_add_u32 s34, s34, 1
    s_cmp_eq_u32 s34, 20
    s_cselect_b32 s34, 0, s34
    v_add_u32 v2, 4096, v4
    s_waitcnt vmcnt(6)
    s_barrier
    s_add_u32 m0, s28, 81920
    s_mul_i32 s22, s34, 12288
    s_add_u32 s22, s22, s26
    buffer_load_dwordx4 v4, s[8:11], s22 offen offset:0 lds
    buffer_load_dwordx4 v4, s[8:11], s22 offen offset:1024 lds
    buffer_load_dwordx4 v4, s[8:11], s22 offen offset:2048 lds
    s_add_u32 m0, s29, 81920
    s_lshl_b32 s22, s34, 11
    s_add_u32 s22, s22, s27
    buffer_load_dwordx4 v4, s[8:11], s22 offen offset:0 lds
    buffer_load_dwordx4 v4, s[8:11], s22 offen offset:1024 lds
    s_add_u32 s34, s34, 1
    s_cmp_eq_u32 s34, 20
    s_cselect_b32 s34, 0, s34
    s_add_u32 m0, s28, 102400
    s_mul_i32 s22, s34, 12288
    s_add_u32 s22, s22, s26
    buffer_load_dwordx4 v4, s[8:11], s22 offen offset:0 lds
    buffer_load_dwordx4 v4, s[8:11], s22 offen offset:1024 lds
    buffer_load_dwordx4 v4, s[8:11], s22 offen offset:2048 lds
    s_add_u32 m0, s29, 102400
    s_lshl_b32 s22, s34, 11
    s_add_u32 s22, s22, s27
    buffer_load_dwordx4 v4, s[8:11], s22 offen offset:0 lds
    buffer_load_dwordx4 v4, s[8:11], s22 offen offset:1024 lds
    s_add_u32 s34, s34, 1
    s_cmp_eq_u32 s34, 20
    s_cselect_b32 s34, 0, s34
    s_waitcnt vmcnt(14)
    s_barrier
    s_add_u32 m0, s28, 122880
    s_mul_i32 s22, s34, 12288
    s_add_u32 s22, s22, s26
    buffer_load_dwordx4 v4, s[8:11], s22 offen offset:0 lds
    buffer_load_dwordx4 v4, s[8:11], s22 offen offset:1024 lds
    buffer_load_dwordx4 v4, s[8:11], s22 offen offset:2048 lds
    s_add_u32 m0, s29, 122880
    s_lshl_b32 s22, s34, 11
    s_add_u32 s22, s22, s27
    buffer_load_dwordx4 v4, s[8:11], s22 offen offset:0 lds
    buffer_load_dwordx4 v4, s[8:11], s22 offen offset:1024 lds
    s_add_u32 s34, s34, 1
    s_cmp_eq_u32 s34, 20
    s_cselect_b32 s34, 0, s34
    s_add_u32 m0, s28, 0
    s_mul_i32 s22, s34, 12288
    s_add_u32 s22, s22, s26
    buffer_load_dwordx4 v4, s[8:11], s22 offen offset:0 lds
    buffer_load_dwordx4 v4, s[8:11], s22 offen offset:1024 lds
    buffer_load_dwordx4 v4, s[8:11], s22 offen offset:2048 lds
    s_add_u32 m0, s29, 0
    s_lshl_b32 s22, s34, 11
    s_add_u32 s22, s22, s27
    buffer_load_dwordx4 v4, s[8:11], s22 offen offset:0 lds
    buffer_load_dwordx4 v4, s[8:11], s22 offen offset:1024 lds
    s_add_u32 s34, s34, 1
    s_cmp_eq_u32 s34, 20
    s_cselect_b32 s34, 0, s34
    s_add_u32 s35, s38, 0
    buffer_load_dwordx4 v[136:139], v4, s[8:11], s35 offen offset:0
    buffer_load_dwordx4 v[140:143], v4, s[8:11], s35 offen offset:1024
    s_waitcnt vmcnt(24)
    s_barrier
    s_add_u32 m0, s28, 20480
    s_mul_i32 s22, s34, 12288
    s_add_u32 s22, s22, s26
    buffer_load_dwordx4 v4, s[8:11], s22 offen offset:0 lds
    buffer_load_dwordx4 v4, s[8:11], s22 offen offset:1024 lds
    buffer_load_dwordx4 v4, s[8:11], s22 offen offset:2048 lds
    s_add_u32 m0, s29, 20480
    s_lshl_b32 s22, s34, 11
    s_add_u32 s22, s22, s27
    buffer_load_dwordx4 v4, s[8:11], s22 offen offset:0 lds
    buffer_load_dwordx4 v4, s[8:11], s22 offen offset:1024 lds
    s_add_u32 s34, s34, 1
    s_cmp_eq_u32 s34, 20
    s_cselect_b32 s34, 0, s34
    buffer_load_dwordx4 v[144:147], v4, s[8:11], s35 offen offset:2048
    buffer_load_dwordx4 v[148:151], v4, s[8:11], s35 offen offset:3072
    s_waitcnt vmcnt(29)
    s_barrier
    s_add_u32 m0, s28, 40960
    s_mul_i32 s22, s34, 12288
    s_add_u32 s22, s22, s26
    buffer_load_dwordx4 v4, s[8:11], s22 offen offset:0 lds
    buffer_load_dwordx4 v4, s[8:11], s22 offen offset:1024 lds
    buffer_load_dwordx4 v4, s[8:11], s22 offen offset:2048 lds
    s_add_u32 m0, s29, 40960
    s_lshl_b32 s22, s34, 11
    s_add_u32 s22, s22, s27
    buffer_load_dwordx4 v4, s[8:11], s22 offen offset:0 lds
    buffer_load_dwordx4 v4, s[8:11], s22 offen offset:1024 lds
    s_add_u32 s34, s34, 1
    s_cmp_eq_u32 s34, 20
    s_cselect_b32 s34, 0, s34
    buffer_load_dwordx4 v[152:155], v2, s[8:11], s35 offen offset:0
    s_add_u32 s35, s38, 40960
    buffer_load_dwordx4 v[156:159], v4, s[8:11], s35 offen offset:0
    s_waitcnt vmcnt(31)
    s_barrier
    s_add_u32 m0, s28, 61440
    s_mul_i32 s22, s34, 12288
    s_add_u32 s22, s22, s26
    buffer_load_dwordx4 v4, s[8:11], s22 offen offset:0 lds
    buffer_load_dwordx4 v4, s[8:11], s22 offen offset:1024 lds
    buffer_load_dwordx4 v4, s[8:11], s22 offen offset:2048 lds
    s_add_u32 m0, s29, 61440
    s_lshl_b32 s22, s34, 11
    s_add_u32 s22, s22, s27
    buffer_load_dwordx4 v4, s[8:11], s22 offen offset:0 lds
    buffer_load_dwordx4 v4, s[8:11], s22 offen offset:1024 lds
    s_add_u32 s34, s34, 1
    s_cmp_eq_u32 s34, 20
    s_cselect_b32 s34, 0, s34
    buffer_load_dwordx4 v[160:163], v4, s[8:11], s35 offen offset:1024
    buffer_load_dwordx4 v[164:167], v4, s[8:11], s35 offen offset:2048
    s_waitcnt vmcnt(33)
    s_barrier
    s_add_u32 m0, s28, 81920
    s_mul_i32 s22, s34, 12288
    s_add_u32 s22, s22, s26
    buffer_load_dwordx4 v4, s[8:11], s22 offen offset:0 lds
    buffer_load_dwordx4 v4, s[8:11], s22 offen offset:1024 lds
    buffer_load_dwordx4 v4, s[8:11], s22 offen offset:2048 lds
    s_add_u32 m0, s29, 81920
    s_lshl_b32 s22, s34, 11
    s_add_u32 s22, s22, s27
    buffer_load_dwordx4 v4, s[8:11], s22 offen offset:0 lds
    buffer_load_dwordx4 v4, s[8:11], s22 offen offset:1024 lds
    s_add_u32 s34, s34, 1
    s_cmp_eq_u32 s34, 20
    s_cselect_b32 s34, 0, s34
    buffer_load_dwordx4 v[168:171], v4, s[8:11], s35 offen offset:3072
    buffer_load_dwordx4 v[172:175], v2, s[8:11], s35 offen offset:0
    s_waitcnt vmcnt(35)
    s_barrier
    s_add_u32 m0, s28, 102400
    s_mul_i32 s22, s34, 12288
    s_add_u32 s22, s22, s26
    buffer_load_dwordx4 v4, s[8:11], s22 offen offset:0 lds
    buffer_load_dwordx4 v4, s[8:11], s22 offen offset:1024 lds
    buffer_load_dwordx4 v4, s[8:11], s22 offen offset:2048 lds
    s_add_u32 m0, s29, 102400
    s_lshl_b32 s22, s34, 11
    s_add_u32 s22, s22, s27
    buffer_load_dwordx4 v4, s[8:11], s22 offen offset:0 lds
    buffer_load_dwordx4 v4, s[8:11], s22 offen offset:1024 lds
    s_add_u32 s34, s34, 1
    s_cmp_eq_u32 s34, 20
    s_cselect_b32 s34, 0, s34
    s_add_u32 s35, s38, 81920
    buffer_load_dwordx4 v[176:179], v4, s[8:11], s35 offen offset:0
    buffer_load_dwordx4 v[180:183], v4, s[8:11], s35 offen offset:1024
    s_waitcnt vmcnt(37)
    s_barrier
    s_add_u32 m0, s28, 122880
    s_mul_i32 s22, s34, 12288
    s_add_u32 s22, s22, s26
    buffer_load_dwordx4 v4, s[8:11], s22 offen offset:0 lds
    buffer_load_dwordx4 v4, s[8:11], s22 offen offset:1024 lds
    buffer_load_dwordx4 v4, s[8:11], s22 offen offset:2048 lds
    s_add_u32 m0, s29, 122880
    s_lshl_b32 s22, s34, 11
    s_add_u32 s22, s22, s27
    buffer_load_dwordx4 v4, s[8:11], s22 offen offset:0 lds
    buffer_load_dwordx4 v4, s[8:11], s22 offen offset:1024 lds
    s_add_u32 s34, s34, 1
    s_cmp_eq_u32 s34, 20
    s_cselect_b32 s34, 0, s34
    buffer_load_dwordx4 v[184:187], v4, s[8:11], s35 offen offset:2048
    buffer_load_dwordx4 v[188:191], v4, s[8:11], s35 offen offset:3072
    s_waitcnt vmcnt(37)
    s_barrier
    s_add_u32 m0, s28, 0
    s_mul_i32 s22, s34, 12288
    s_add_u32 s22, s22, s26
    buffer_load_dwordx4 v4, s[8:11], s22 offen offset:0 lds
    buffer_load_dwordx4 v4, s[8:11], s22 offen offset:1024 lds
    buffer_load_dwordx4 v4, s[8:11], s22 offen offset:2048 lds
    s_add_u32 m0, s29, 0
    s_lshl_b32 s22, s34, 11
    s_add_u32 s22, s22, s27
    buffer_load_dwordx4 v4, s[8:11], s22 offen offset:0 lds
    buffer_load_dwordx4 v4, s[8:11], s22 offen offset:1024 lds
    s_add_u32 s34, s34, 1
    s_cmp_eq_u32 s34, 20
    s_cselect_b32 s34, 0, s34
    buffer_load_dwordx4 v[192:195], v2, s[8:11], s35 offen offset:0
    s_add_u32 s35, s38, 122880
    buffer_load_dwordx4 v[196:199], v4, s[8:11], s35 offen offset:0
    s_waitcnt vmcnt(37)
    s_barrier
    s_add_u32 m0, s28, 20480
    s_mul_i32 s22, s34, 12288
    s_add_u32 s22, s22, s26
    buffer_load_dwordx4 v4, s[8:11], s22 offen offset:0 lds
    buffer_load_dwordx4 v4, s[8:11], s22 offen offset:1024 lds
    buffer_load_dwordx4 v4, s[8:11], s22 offen offset:2048 lds
    s_add_u32 m0, s29, 20480
    s_lshl_b32 s22, s34, 11
    s_add_u32 s22, s22, s27
    buffer_load_dwordx4 v4, s[8:11], s22 offen offset:0 lds
    buffer_load_dwordx4 v4, s[8:11], s22 offen offset:1024 lds
    s_add_u32 s34, s34, 1
    s_cmp_eq_u32 s34, 20
    s_cselect_b32 s34, 0, s34
    buffer_load_dwordx4 v[200:203], v4, s[8:11], s35 offen offset:1024
    buffer_load_dwordx4 v[204:207], v4, s[8:11], s35 offen offset:2048
    s_waitcnt vmcnt(37)
    s_barrier
    s_add_u32 m0, s28, 40960
    s_mul_i32 s22, s34, 12288
    s_add_u32 s22, s22, s26
    buffer_load_dwordx4 v4, s[8:11], s22 offen offset:0 lds
    buffer_load_dwordx4 v4, s[8:11], s22 offen offset:1024 lds
    buffer_load_dwordx4 v4, s[8:11], s22 offen offset:2048 lds
    s_add_u32 m0, s29, 40960
    s_lshl_b32 s22, s34, 11
    s_add_u32 s22, s22, s27
    buffer_load_dwordx4 v4, s[8:11], s22 offen offset:0 lds
    buffer_load_dwordx4 v4, s[8:11], s22 offen offset:1024 lds
    s_add_u32 s34, s34, 1
    s_cmp_eq_u32 s34, 20
    s_cselect_b32 s34, 0, s34
    buffer_load_dwordx4 v[208:211], v4, s[8:11], s35 offen offset:3072
    buffer_load_dwordx4 v[212:215], v2, s[8:11], s35 offen offset:0
    s_waitcnt vmcnt(37)
    s_barrier
    s_add_u32 m0, s28, 61440
    s_mul_i32 s22, s34, 12288
    s_add_u32 s22, s22, s26
    buffer_load_dwordx4 v4, s[8:11], s22 offen offset:0 lds
    buffer_load_dwordx4 v4, s[8:11], s22 offen offset:1024 lds
    buffer_load_dwordx4 v4, s[8:11], s22 offen offset:2048 lds
    s_add_u32 m0, s29, 61440
    s_lshl_b32 s22, s34, 11
    s_add_u32 s22, s22, s27
    buffer_load_dwordx4 v4, s[8:11], s22 offen offset:0 lds
    buffer_load_dwordx4 v4, s[8:11], s22 offen offset:1024 lds
    s_add_u32 s34, s34, 1
    s_cmp_eq_u32 s34, 20
    s_cselect_b32 s34, 0, s34
    s_add_u32 s35, s38, 163840
    buffer_load_dwordx4 v[216:219], v4, s[8:11], s35 offen offset:0
    buffer_load_dwordx4 v[220:223], v4, s[8:11], s35 offen offset:1024
    s_waitcnt vmcnt(37)
    s_barrier
    s_add_u32 m0, s28, 81920
    s_mul_i32 s22, s34, 12288
    s_add_u32 s22, s22, s26
    buffer_load_dwordx4 v4, s[8:11], s22 offen offset:0 lds
    buffer_load_dwordx4 v4, s[8:11], s22 offen offset:1024 lds
    buffer_load_dwordx4 v4, s[8:11], s22 offen offset:2048 lds
    s_add_u32 m0, s29, 81920
    s_lshl_b32 s22, s34, 11
    s_add_u32 s22, s22, s27
    buffer_load_dwordx4 v4, s[8:11], s22 offen offset:0 lds
    buffer_load_dwordx4 v4, s[8:11], s22 offen offset:1024 lds
    s_add_u32 s34, s34, 1
    s_cmp_eq_u32 s34, 20
    s_cselect_b32 s34, 0, s34
    buffer_load_dwordx4 v[224:227], v4, s[8:11], s35 offen offset:2048
    buffer_load_dwordx4 v[228:231], v4, s[8:11], s35 offen offset:3072
    s_waitcnt vmcnt(37)
    s_barrier
    s_add_u32 m0, s28, 102400
    s_mul_i32 s22, s34, 12288
    s_add_u32 s22, s22, s26
    buffer_load_dwordx4 v4, s[8:11], s22 offen offset:0 lds
    buffer_load_dwordx4 v4, s[8:11], s22 offen offset:1024 lds
    buffer_load_dwordx4 v4, s[8:11], s22 offen offset:2048 lds
    s_add_u32 m0, s29, 102400
    s_lshl_b32 s22, s34, 11
    s_add_u32 s22, s22, s27
    buffer_load_dwordx4 v4, s[8:11], s22 offen offset:0 lds
    buffer_load_dwordx4 v4, s[8:11], s22 offen offset:1024 lds
    s_add_u32 s34, s34, 1
    s_cmp_eq_u32 s34, 20
    s_cselect_b32 s34, 0, s34
    buffer_load_dwordx4 v[232:235], v2, s[8:11], s35 offen offset:0
    s_add_u32 s35, s38, 204800
    buffer_load_dwordx4 v[236:239], v4, s[8:11], s35 offen offset:0
    s_waitcnt vmcnt(37)
    s_barrier
    buffer_load_dwordx4 v[240:243], v4, s[8:11], s35 offen offset:1024
    buffer_load_dwordx4 v[244:247], v4, s[8:11], s35 offen offset:2048
    s_waitcnt vmcnt(32)
    s_barrier
    buffer_load_dwordx4 v[248:251], v4, s[8:11], s35 offen offset:3072
    buffer_load_dwordx4 v[252:255], v2, s[8:11], s35 offen offset:0
    s_waitcnt vmcnt(27)
    s_barrier
    s_waitcnt vmcnt(20)
    s_barrier
    s_waitcnt vmcnt(13)
    s_barrier
    s_waitcnt vmcnt(6)
    s_barrier
    s_barrier
    s_mul_i32 s22, s21, 6
    s_add_u32 s23, s21, 0
    s_and_b32 s23, s23, 3
    s_lshl_b32 s24, s36, 2
    s_add_u32 s23, s23, s24
    s_mul_i32 s23, s23, 48
    s_add_u32 s23, s23, s22
    s_lshl_b32 s23, s23, 10
    s_add_u32 s40, s23, 10485760
    s_add_u32 s23, s21, 1
    s_and_b32 s23, s23, 3
    s_lshl_b32 s24, s36, 2
    s_add_u32 s23, s23, s24
    s_mul_i32 s23, s23, 48
    s_add_u32 s23, s23, s22
    s_lshl_b32 s23, s23, 10
    s_add_u32 s41, s23, 10485760
    s_add_u32 s23, s21, 2
    s_and_b32 s23, s23, 3
    s_lshl_b32 s24, s36, 2
    s_add_u32 s23, s23, s24
    s_mul_i32 s23, s23, 48
    s_add_u32 s23, s23, s22
    s_lshl_b32 s23, s23, 10
    s_add_u32 s42, s23, 10485760
    s_add_u32 s23, s21, 3
    s_and_b32 s23, s23, 3
    s_lshl_b32 s24, s36, 2
    s_add_u32 s23, s23, s24
    s_mul_i32 s23, s23, 48
    s_add_u32 s23, s23, s22
    s_lshl_b32 s23, s23, 10
    s_add_u32 s43, s23, 10485760
    s_lshl_b32 s23, s36, 5
    s_lshl_b32 s24, s21, 2
    s_add_u32 s23, s23, s24
    s_lshl_b32 s23, s23, 7
    s_add_u32 s39, s23, 24117248
    v_and_b32 v3, 3, v1
    v_lshlrev_b32 v3, 7, v3
    s_add_u32 s23, s21, 0
    s_and_b32 s23, s23, 3
    s_sub_u32 s24, s21, s23
    s_sub_u32 s24, s24, 1
    s_and_b32 s24, s24, 7
    s_mul_i32 s24, s24, 3072
    s_mul_i32 s23, s23, 21504
    s_add_u32 s44, s23, s24
    s_add_u32 s23, s21, 0
    s_and_b32 s23, s23, 3
    s_sub_u32 s24, s21, s23
    s_sub_u32 s24, s24, 5
    s_and_b32 s24, s24, 7
    s_mul_i32 s24, s24, 2048
    s_mul_i32 s23, s23, 14336
    s_add_u32 s45, s23, s24
    s_add_u32 s45, s45, 86016
    s_add_u32 s23, s21, 1
    s_and_b32 s23, s23, 3
    s_sub_u32 s24, s21, s23
    s_sub_u32 s24, s24, 1
    s_and_b32 s24, s24, 7
    s_mul_i32 s24, s24, 3072
    s_mul_i32 s23, s23, 21504
    s_add_u32 s46, s23, s24
    s_add_u32 s23, s21, 1
    s_and_b32 s23, s23, 3
    s_sub_u32 s24, s21, s23
    s_sub_u32 s24, s24, 5
    s_and_b32 s24, s24, 7
    s_mul_i32 s24, s24, 2048
    s_mul_i32 s23, s23, 14336
    s_add_u32 s47, s23, s24
    s_add_u32 s47, s47, 86016
    s_add_u32 s23, s21, 2
    s_and_b32 s23, s23, 3
    s_sub_u32 s24, s21, s23
    s_sub_u32 s24, s24, 1
    s_and_b32 s24, s24, 7
    s_mul_i32 s24, s24, 3072
    s_mul_i32 s23, s23, 21504
    s_add_u32 s48, s23, s24
    s_add_u32 s23, s21, 2
    s_and_b32 s23, s23, 3
    s_sub_u32 s24, s21, s23
    s_sub_u32 s24, s24, 5
    s_and_b32 s24, s24, 7
    s_mul_i32 s24, s24, 2048
    s_mul_i32 s23, s23, 14336
    s_add_u32 s49, s23, s24
    s_add_u32 s49, s49, 86016
    s_add_u32 s23, s21, 3
    s_and_b32 s23, s23, 3
    s_sub_u32 s24, s21, s23
    s_sub_u32 s24, s24, 1
    s_and_b32 s24, s24, 7
    s_mul_i32 s24, s24, 3072
    s_mul_i32 s23, s23, 21504
    s_add_u32 s50, s23, s24
    s_add_u32 s23, s21, 3
    s_and_b32 s23, s23, 3
    s_sub_u32 s24, s21, s23
    s_sub_u32 s24, s24, 5
    s_and_b32 s24, s24, 7
    s_mul_i32 s24, s24, 2048
    s_mul_i32 s23, s23, 14336
    s_add_u32 s51, s23, s24
    s_add_u32 s51, s51, 86016
    s_and_b32 s53, s21, 3
    s_mul_i32 s52, s53, 14336
    s_add_u32 s52, s52, 86016
    v_lshrrev_b32 v6, 4, v1
    v_and_b32 v7, 15, v1
    v_lshrrev_b32 v8, 1, v6
    v_lshlrev_b32 v8, 9, v8
    v_lshl_add_u32 v8, v7, 4, v8
    v_and_b32 v5, 1, v6
    v_lshl_add_u32 v5, v5, 3, v8
    v_mul_u32_u24 v8, 1280, v7
    v_lshl_add_u32 v6, v6, 3, v8
    v_lshlrev_b32 v7, 2, v7
    s_lshl_b32 s22, s36, 1
    s_lshr_b32 s23, s53, 1
    s_add_u32 s22, s22, s23
    s_mul_i32 s22, s22, 40
    s_mul_i32 s23, s37, 5
    s_add_u32 s22, s22, s23
    s_add_u32 s22, s22, 3
    s_lshl_b32 s22, s22, 10
    s_and_b32 s23, s53, 1
    s_lshl_b32 s23, s23, 8
    s_add_u32 s22, s22, s23
    s_add_u32 s54, s22, 7864320
    s_lshl_b32 s22, s36, 2
    s_add_u32 s22, s22, s53
    s_lshl_b32 s23, s22, 6
    s_add_u32 s55, s23, 16777216
    s_mul_i32 s56, s22, 20480
    s_mul_i32 s23, s37, 160
    s_add_u32 s56, s56, s23
    s_mov_b32 s57, 20000
k1_kernel_poll25:
    buffer_load_dword v8, v3, s[8:11], s39 offen sc1
    s_sub_u32 s57, s57, 1
    s_cmp_eq_u32 s57, 0
    s_cbranch_scc1 k1_kernel_got26
    s_waitcnt vmcnt(0)
    v_cmp_ne_u32 vcc, s78, v8
    s_cmp_lg_u64 vcc, 0
    s_cbranch_scc1 k1_kernel_poll25
k1_kernel_got26:
    s_waitcnt vmcnt(0)
    buffer_load_dwordx4 v[8:11], v4, s[8:11], s40 offen offset:0
    buffer_load_dwordx4 v[12:15], v4, s[8:11], s41 offen offset:0
    buffer_load_dwordx4 v[16:19], v4, s[8:11], s42 offen offset:0
    buffer_load_dwordx4 v[20:23], v4, s[8:11], s43 offen offset:0
    buffer_load_dwordx4 v[24:27], v4, s[8:11], s40 offen offset:1024
    buffer_load_dwordx4 v[28:31], v4, s[8:11], s41 offen offset:1024
    buffer_load_dwordx4 v[32:35], v4, s[8:11], s42 offen offset:1024
    buffer_load_dwordx4 v[36:39], v4, s[8:11], s43 offen offset:1024
    buffer_load_dwordx4 v[120:123], v4, s[8:11], s40 offen offset:2048
    buffer_load_dwordx4 v[124:127], v4, s[8:11], s41 offen offset:2048
    buffer_load_dwordx4 v[128:131], v4, s[8:11], s42 offen offset:2048
    buffer_load_dwordx4 v[132:135], v4, s[8:11], s43 offen offset:2048
    s_waitcnt vmcnt(8)
    v_mfma_f32_16x16x32_bf16 v[40:43], v[136:139], v[8:11], 0
    v_mfma_f32_16x16x32_bf16 v[44:47], v[140:143], v[8:11], 0
    v_mfma_f32_16x16x32_bf16 v[48:51], v[144:147], v[8:11], 0
    v_mfma_f32_16x16x32_bf16 v[52:55], v[148:151], v[8:11], 0
    v_mfma_f32_16x16x32_bf16 v[56:59], v[152:155], v[8:11], 0
    buffer_load_dwordx4 v[8:11], v4, s[8:11], s40 offen offset:3072
    v_mfma_f32_16x16x32_bf16 v[60:63], v[136:139], v[12:15], 0
    v_mfma_f32_16x16x32_bf16 v[64:67], v[140:143], v[12:15], 0
    v_mfma_f32_16x16x32_bf16 v[68:71], v[144:147], v[12:15], 0
    v_mfma_f32_16x16x32_bf16 v[72:75], v[148:151], v[12:15], 0
    v_mfma_f32_16x16x32_bf16 v[76:79], v[152:155], v[12:15], 0
    buffer_load_dwordx4 v[12:15], v4, s[8:11], s41 offen offset:3072
    v_mfma_f32_16x16x32_bf16 v[80:83], v[136:139], v[16:19], 0
    v_mfma_f32_16x16x32_bf16 v[84:87], v[140:143], v[16:19], 0
    v_mfma_f32_16x16x32_bf16 v[88:91], v[144:147], v[16:19], 0
    v_mfma_f32_16x16x32_bf16 v[92:95], v[148:151], v[16:19], 0
    v_mfma_f32_16x16x32_bf16 v[96:99], v[152:155], v[16:19], 0
    buffer_load_dwordx4 v[16:19], v4, s[8:11], s42 offen offset:3072
    v_mfma_f32_16x16x32_bf16 v[100:103], v[136:139], v[20:23], 0
    v_mfma_f32_16x16x32_bf16 v[104:107], v[140:143], v[20:23], 0
    v_mfma_f32_16x16x32_bf16 v[108:111], v[144:147], v[20:23], 0
    v_mfma_f32_16x16x32_bf16 v[112:115], v[148:151], v[20:23], 0
    v_mfma_f32_16x16x32_bf16 v[116:119], v[152:155], v[20:23], 0
    buffer_load_dwordx4 v[20:23], v4, s[8:11], s43 offen offset:3072
    s_waitcnt vmcnt(8)
    v_mfma_f32_16x16x32_bf16 v[40:43], v[156:159], v[24:27], v[40:43]
    v_mfma_f32_16x16x32_bf16 v[44:47], v[160:163], v[24:27], v[44:47]
    v_mfma_f32_16x16x32_bf16 v[48:51], v[164:167], v[24:27], v[48:51]
    v_mfma_f32_16x16x32_bf16 v[52:55], v[168:171], v[24:27], v[52:55]
    v_mfma_f32_16x16x32_bf16 v[56:59], v[172:175], v[24:27], v[56:59]
    buffer_load_dwordx4 v[136:139], v2, s[8:11], s40 offen offset:0
    v_mfma_f32_16x16x32_bf16 v[60:63], v[156:159], v[28:31], v[60:63]
    v_mfma_f32_16x16x32_bf16 v[64:67], v[160:163], v[28:31], v[64:67]
    v_mfma_f32_16x16x32_bf16 v[68:71], v[164:167], v[28:31], v[68:71]
    v_mfma_f32_16x16x32_bf16 v[72:75], v[168:171], v[28:31], v[72:75]
    v_mfma_f32_16x16x32_bf16 v[76:79], v[172:175], v[28:31], v[76:79]
    buffer_load_dwordx4 v[140:143], v2, s[8:11], s41 offen offset:0
    v_mfma_f32_16x16x32_bf16 v[80:83], v[156:159], v[32:35], v[80:83]
    v_mfma_f32_16x16x32_bf16 v[84:87], v[160:163], v[32:35], v[84:87]
    v_mfma_f32_16x16x32_bf16 v[88:91], v[164:167], v[32:35], v[88:91]
    v_mfma_f32_16x16x32_bf16 v[92:95], v[168:171], v[32:35], v[92:95]
    v_mfma_f32_16x16x32_bf16 v[96:99], v[172:175], v[32:35], v[96:99]
    buffer_load_dwordx4 v[144:147], v2, s[8:11], s42 offen offset:0
    v_mfma_f32_16x16x32_bf16 v[100:103], v[156:159], v[36:39], v[100:103]
    v_mfma_f32_16x16x32_bf16 v[104:107], v[160:163], v[36:39], v[104:107]
    v_mfma_f32_16x16x32_bf16 v[108:111], v[164:167], v[36:39], v[108:111]
    v_mfma_f32_16x16x32_bf16 v[112:115], v[168:171], v[36:39], v[112:115]
    v_mfma_f32_16x16x32_bf16 v[116:119], v[172:175], v[36:39], v[116:119]
    buffer_load_dwordx4 v[148:151], v2, s[8:11], s43 offen offset:0
    s_waitcnt vmcnt(8)
    v_mfma_f32_16x16x32_bf16 v[40:43], v[176:179], v[120:123], v[40:43]
    v_mfma_f32_16x16x32_bf16 v[44:47], v[180:183], v[120:123], v[44:47]
    v_mfma_f32_16x16x32_bf16 v[48:51], v[184:187], v[120:123], v[48:51]
    v_mfma_f32_16x16x32_bf16 v[52:55], v[188:191], v[120:123], v[52:55]
    v_mfma_f32_16x16x32_bf16 v[56:59], v[192:195], v[120:123], v[56:59]
    buffer_load_dwordx4 v[24:27], v2, s[8:11], s40 offen offset:1024
    buffer_load_dwordx4 v[28:31], v2, s[8:11], s41 offen offset:1024
    buffer_load_dwordx4 v[32:35], v2, s[8:11], s42 offen offset:1024
    buffer_load_dwordx4 v[36:39], v2, s[8:11], s43 offen offset:1024
    v_mfma_f32_16x16x32_bf16 v[60:63], v[176:179], v[124:127], v[60:63]
    v_mfma_f32_16x16x32_bf16 v[64:67], v[180:183], v[124:127], v[64:67]
    v_mfma_f32_16x16x32_bf16 v[68:71], v[184:187], v[124:127], v[68:71]
    v_mfma_f32_16x16x32_bf16 v[72:75], v[188:191], v[124:127], v[72:75]
    v_mfma_f32_16x16x32_bf16 v[76:79], v[192:195], v[124:127], v[76:79]
    buffer_load_dwordx2 v[156:157], v5, s[8:11], s54 offen offset:0
    buffer_load_dwordx2 v[158:159], v5, s[8:11], s54 offen offset:1024
    buffer_load_dword v164, v7, s[8:11], s55 offen
    v_mfma_f32_16x16x32_bf16 v[80:83], v[176:179], v[128:131], v[80:83]
    v_mfma_f32_16x16x32_bf16 v[84:87], v[180:183], v[128:131], v[84:87]
    v_mfma_f32_16x16x32_bf16 v[88:91], v[184:187], v[128:131], v[88:91]
    v_mfma_f32_16x16x32_bf16 v[92:95], v[188:191], v[128:131], v[92:95]
    v_mfma_f32_16x16x32_bf16 v[96:99], v[192:195], v[128:131], v[96:99]
    v_mfma_f32_16x16x32_bf16 v[100:103], v[176:179], v[132:135], v[100:103]
    v_mfma_f32_16x16x32_bf16 v[104:107], v[180:183], v[132:135], v[104:107]
    v_mfma_f32_16x16x32_bf16 v[108:111], v[184:187], v[132:135], v[108:111]
    v_mfma_f32_16x16x32_bf16 v[112:115], v[188:191], v[132:135], v[112:115]
    v_mfma_f32_16x16x32_bf16 v[116:119], v[192:195], v[132:135], v[116:119]
    s_waitcnt vmcnt(11)
    v_mfma_f32_16x16x32_bf16 v[40:43], v[196:199], v[8:11], v[40:43]
    v_mfma_f32_16x16x32_bf16 v[44:47], v[200:203], v[8:11], v[44:47]
    v_mfma_f32_16x16x32_bf16 v[48:51], v[204:207], v[8:11], v[48:51]
    v_mfma_f32_16x16x32_bf16 v[52:55], v[208:211], v[8:11], v[52:55]
    v_mfma_f32_16x16x32_bf16 v[56:59], v[212:215], v[8:11], v[56:59]
    v_mfma_f32_16x16x32_bf16 v[60:63], v[196:199], v[12:15], v[60:63]
    v_mfma_f32_16x16x32_bf16 v[64:67], v[200:203], v[12:15], v[64:67]
    v_mfma_f32_16x16x32_bf16 v[68:71], v[204:207], v[12:15], v[68:71]
    v_mfma_f32_16x16x32_bf16 v[72:75], v[208:211], v[12:15], v[72:75]
    v_mfma_f32_16x16x32_bf16 v[76:79], v[212:215], v[12:15], v[76:79]
    v_mfma_f32_16x16x32_bf16 v[80:83], v[196:199], v[16:19], v[80:83]
    v_mfma_f32_16x16x32_bf16 v[84:87], v[200:203], v[16:19], v[84:87]
    v_mfma_f32_16x16x32_bf16 v[88:91], v[204:207], v[16:19], v[88:91]
    v_mfma_f32_16x16x32_bf16 v[92:95], v[208:211], v[16:19], v[92:95]
    v_mfma_f32_16x16x32_bf16 v[96:99], v[212:215], v[16:19], v[96:99]
    v_mfma_f32_16x16x32_bf16 v[100:103], v[196:199], v[20:23], v[100:103]
    v_mfma_f32_16x16x32_bf16 v[104:107], v[200:203], v[20:23], v[104:107]
    v_mfma_f32_16x16x32_bf16 v[108:111], v[204:207], v[20:23], v[108:111]
    v_mfma_f32_16x16x32_bf16 v[112:115], v[208:211], v[20:23], v[112:115]
    v_mfma_f32_16x16x32_bf16 v[116:119], v[212:215], v[20:23], v[116:119]
    s_waitcnt vmcnt(7)
    v_mfma_f32_16x16x32_bf16 v[40:43], v[216:219], v[136:139], v[40:43]
    v_mfma_f32_16x16x32_bf16 v[44:47], v[220:223], v[136:139], v[44:47]
    v_mfma_f32_16x16x32_bf16 v[48:51], v[224:227], v[136:139], v[48:51]
    v_mfma_f32_16x16x32_bf16 v[52:55], v[228:231], v[136:139], v[52:55]
    v_mfma_f32_16x16x32_bf16 v[56:59], v[232:235], v[136:139], v[56:59]
    v_mfma_f32_16x16x32_bf16 v[60:63], v[216:219], v[140:143], v[60:63]
    v_mfma_f32_16x16x32_bf16 v[64:67], v[220:223], v[140:143], v[64:67]
    v_mfma_f32_16x16x32_bf16 v[68:71], v[224:227], v[140:143], v[68:71]
    v_mfma_f32_16x16x32_bf16 v[72:75], v[228:231], v[140:143], v[72:75]
    v_mfma_f32_16x16x32_bf16 v[76:79], v[232:235], v[140:143], v[76:79]
    v_mfma_f32_16x16x32_bf16 v[80:83], v[216:219], v[144:147], v[80:83]
    v_mfma_f32_16x16x32_bf16 v[84:87], v[220:223], v[144:147], v[84:87]
    v_mfma_f32_16x16x32_bf16 v[88:91], v[224:227], v[144:147], v[88:91]
    v_mfma_f32_16x16x32_bf16 v[92:95], v[228:231], v[144:147], v[92:95]
    v_mfma_f32_16x16x32_bf16 v[96:99], v[232:235], v[144:147], v[96:99]
    v_mfma_f32_16x16x32_bf16 v[100:103], v[216:219], v[148:151], v[100:103]
    v_mfma_f32_16x16x32_bf16 v[104:107], v[220:223], v[148:151], v[104:107]
    v_mfma_f32_16x16x32_bf16 v[108:111], v[224:227], v[148:151], v[108:111]
    v_mfma_f32_16x16x32_bf16 v[112:115], v[228:231], v[148:151], v[112:115]
    v_mfma_f32_16x16x32_bf16 v[116:119], v[232:235], v[148:151], v[116:119]
    s_waitcnt vmcnt(3)
    v_mfma_f32_16x16x32_bf16 v[40:43], v[236:239], v[24:27], v[40:43]
    v_mfma_f32_16x16x32_bf16 v[44:47], v[240:243], v[24:27], v[44:47]
    v_mfma_f32_16x16x32_bf16 v[48:51], v[244:247], v[24:27], v[48:51]
    v_mfma_f32_16x16x32_bf16 v[52:55], v[248:251], v[24:27], v[52:55]
    v_mfma_f32_16x16x32_bf16 v[56:59], v[252:255], v[24:27], v[56:59]
    v_mfma_f32_16x16x32_bf16 v[60:63], v[236:239], v[28:31], v[60:63]
    v_mfma_f32_16x16x32_bf16 v[64:67], v[240:243], v[28:31], v[64:67]
    v_mfma_f32_16x16x32_bf16 v[68:71], v[244:247], v[28:31], v[68:71]
    v_mfma_f32_16x16x32_bf16 v[72:75], v[248:251], v[28:31], v[72:75]
    v_mfma_f32_16x16x32_bf16 v[76:79], v[252:255], v[28:31], v[76:79]
    v_mfma_f32_16x16x32_bf16 v[80:83], v[236:239], v[32:35], v[80:83]
    v_mfma_f32_16x16x32_bf16 v[84:87], v[240:243], v[32:35], v[84:87]
    v_mfma_f32_16x16x32_bf16 v[88:91], v[244:247], v[32:35], v[88:91]
    v_mfma_f32_16x16x32_bf16 v[92:95], v[248:251], v[32:35], v[92:95]
    v_mfma_f32_16x16x32_bf16 v[96:99], v[252:255], v[32:35], v[96:99]
    v_mfma_f32_16x16x32_bf16 v[100:103], v[236:239], v[36:39], v[100:103]
    v_mfma_f32_16x16x32_bf16 v[104:107], v[240:243], v[36:39], v[104:107]
    v_mfma_f32_16x16x32_bf16 v[108:111], v[244:247], v[36:39], v[108:111]
    v_mfma_f32_16x16x32_bf16 v[112:115], v[248:251], v[36:39], v[112:115]
    v_mfma_f32_16x16x32_bf16 v[116:119], v[252:255], v[36:39], v[116:119]
    s_nop 4
    v_add_u32 v122, s46, v4
    ds_write_b128 v122, v[60:63] offset:0
    ds_write_b128 v122, v[64:67] offset:1024
    ds_write_b128 v122, v[68:71] offset:2048
    v_add_u32 v123, s47, v4
    ds_write_b128 v123, v[72:75] offset:0
    ds_write_b128 v123, v[76:79] offset:1024
    v_add_u32 v124, s48, v4
    ds_write_b128 v124, v[80:83] offset:0
    ds_write_b128 v124, v[84:87] offset:1024
    ds_write_b128 v124, v[88:91] offset:2048
    v_add_u32 v125, s49, v4
    ds_write_b128 v125, v[92:95] offset:0
    ds_write_b128 v125, v[96:99] offset:1024
    v_add_u32 v126, s50, v4
    ds_write_b128 v126, v[100:103] offset:0
    ds_write_b128 v126, v[104:107] offset:1024
    ds_write_b128 v126, v[108:111] offset:2048
    v_add_u32 v127, s51, v4
    ds_write_b128 v127, v[112:115] offset:0
    ds_write_b128 v127, v[116:119] offset:1024
    v_add_u32 v120, s44, v4
    ds_write_b128 v120, v[40:43] offset:0
    ds_write_b128 v120, v[44:47] offset:1024
    ds_write_b128 v120, v[48:51] offset:2048
    v_add_u32 v128, s52, v4
    s_waitcnt lgkmcnt(0)
    s_barrier
    ds_read_b128 v[168:171], v128 offset:0
    ds_read_b128 v[172:175], v128 offset:1024
    ds_read_b128 v[176:179], v128 offset:2048
    ds_read_b128 v[180:183], v128 offset:3072
    ds_read_b128 v[184:187], v128 offset:4096
    ds_read_b128 v[188:191], v128 offset:5120
    ds_read_b128 v[192:195], v128 offset:6144
    ds_read_b128 v[196:199], v128 offset:7168
    ds_read_b128 v[200:203], v128 offset:8192
    ds_read_b128 v[204:207], v128 offset:9216
    ds_read_b128 v[208:211], v128 offset:10240
    ds_read_b128 v[212:215], v128 offset:11264
    ds_read_b128 v[216:219], v128 offset:12288
    ds_read_b128 v[220:223], v128 offset:13312
    s_waitcnt vmcnt(0)
    v_lshlrev_b32 v8, 16, v156
    v_and_b32 v9, 0xffff0000, v156
    v_lshlrev_b32 v10, 16, v157
    v_and_b32 v11, 0xffff0000, v157
    v_lshlrev_b32 v12, 16, v158
    v_and_b32 v13, 0xffff0000, v158
    v_lshlrev_b32 v14, 16, v159
    v_and_b32 v15, 0xffff0000, v159
    v_pk_add_f32 v[8:9], v[8:9], v[164:165] op_sel_hi:[1,0]
    v_pk_add_f32 v[10:11], v[10:11], v[164:165] op_sel_hi:[1,0]
    v_pk_add_f32 v[12:13], v[12:13], v[164:165] op_sel_hi:[1,0]
    v_pk_add_f32 v[14:15], v[14:15], v[164:165] op_sel_hi:[1,0]
    v_pk_add_f32 v[8:9], v[8:9], v[52:53]
    v_pk_add_f32 v[10:11], v[10:11], v[54:55]
    v_pk_add_f32 v[12:13], v[12:13], v[56:57]
    v_pk_add_f32 v[14:15], v[14:15], v[58:59]
    s_waitcnt lgkmcnt(10)
    v_pk_add_f32 v[168:169], v[168:169], v[176:177]
    v_pk_add_f32 v[170:171], v[170:171], v[178:179]
    v_pk_add_f32 v[172:173], v[172:173], v[180:181]
    v_pk_add_f32 v[174:175], v[174:175], v[182:183]
    s_waitcnt lgkmcnt(8)
    v_pk_add_f32 v[8:9], v[8:9], v[184:185]
    v_pk_add_f32 v[10:11], v[10:11], v[186:187]
    v_pk_add_f32 v[12:13], v[12:13], v[188:189]
    v_pk_add_f32 v[14:15], v[14:15], v[190:191]
    s_waitcnt lgkmcnt(6)
    v_pk_add_f32 v[168:169], v[168:169], v[192:193]
    v_pk_add_f32 v[170:171], v[170:171], v[194:195]
    v_pk_add_f32 v[172:173], v[172:173], v[196:197]
    v_pk_add_f32 v[174:175], v[174:175], v[198:199]
    s_waitcnt lgkmcnt(4)
    v_pk_add_f32 v[8:9], v[8:9], v[200:201]
    v_pk_add_f32 v[10:11], v[10:11], v[202:203]
    v_pk_add_f32 v[12:13], v[12:13], v[204:205]
    v_pk_add_f32 v[14:15], v[14:15], v[206:207]
    s_waitcnt lgkmcnt(2)
    v_pk_add_f32 v[168:169], v[168:169], v[208:209]
    v_pk_add_f32 v[170:171], v[170:171], v[210:211]
    v_pk_add_f32 v[172:173], v[172:173], v[212:213]
    v_pk_add_f32 v[174:175], v[174:175], v[214:215]
    s_waitcnt lgkmcnt(0)
    v_pk_add_f32 v[8:9], v[8:9], v[216:217]
    v_pk_add_f32 v[10:11], v[10:11], v[218:219]
    v_pk_add_f32 v[12:13], v[12:13], v[220:221]
    v_pk_add_f32 v[14:15], v[14:15], v[222:223]
    v_pk_add_f32 v[8:9], v[8:9], v[168:169]
    v_pk_add_f32 v[10:11], v[10:11], v[170:171]
    v_pk_add_f32 v[12:13], v[12:13], v[172:173]
    v_pk_add_f32 v[14:15], v[14:15], v[174:175]
    v_cvt_pk_bf16_f32 v24, v8, v9
    v_cvt_pk_bf16_f32 v25, v10, v11
    buffer_store_dwordx2 v[24:25], v6, s[12:15], s56 offen offset:96
    v_cvt_pk_bf16_f32 v26, v12, v13
    v_cvt_pk_bf16_f32 v27, v14, v15
    buffer_store_dwordx2 v[26:27], v6, s[12:15], s56 offen offset:128
    s_endpgm
k345_end:
    s_endpgm
k1_kernel_end:
    s_endpgm
k1_kernel_codeend:
.section .rodata,"a"
.p2align 6
.amdhsa_kernel k1_kernel
  .amdhsa_next_free_vgpr 256
  .amdhsa_next_free_sgpr 102
  .amdhsa_accum_offset 256
  .amdhsa_group_segment_fixed_size 0
  .amdhsa_kernarg_size 80
  .amdhsa_user_sgpr_count 2
  .amdhsa_user_sgpr_kernarg_segment_ptr 1
  .amdhsa_system_sgpr_workgroup_id_x 1
.end_amdhsa_kernel
```
